```python
import torch

def _softmax(x, axis=-1):
    return torch.softmax(x, dim=axis)
def _gelu(x):
    return torch.nn.functional.gelu(x, approximate="tanh")
def _silu(x):
    return torch.nn.functional.silu(x)
def _sigmoid(x):
    return torch.sigmoid(x)
def _layernorm(x, axis=-1, eps=1e-5):
    m = x.mean(dim=axis, keepdim=True)
    v = x.var(dim=axis, keepdim=True, unbiased=False)
    return (x - m) / torch.sqrt(v + eps)
def _scatter_add(tgt, idx, src, axis=0):
    return tgt.clone().index_add_(axis, idx, src)
def _segment_sum(src, seg, n):
    out = torch.zeros((n,) + src.shape[1:], dtype=src.dtype)
    return out.index_add_(0, seg, src)
def _pad(x, pw):
    flat = tuple(v for pair in reversed(pw) for v in pair)
    return torch.nn.functional.pad(x, flat)

kernel_name = 'gather_scatter__mpnn_edge_mlp__graph'

def setup_inputs():

    _w = (lambda a: (lambda t: t.to(torch.bfloat16) if t.is_floating_point() else t)(torch.as_tensor(a)))
    N, deg, D, De = 10000, 16, 128, max(4, 1)
    E = N * deg
    return {
        "x": _w((lambda *s: torch.randn(*s, dtype=torch.bfloat16) * 0.05)(N, D)),
        "e_attr": _w((lambda *s: torch.randn(*s, dtype=torch.bfloat16) * 0.4)(E, De)),
        "src": _w((lambda lo, hi, *s: torch.randint(lo, hi, s))(0, N, E).to(torch.int64)),
        "dst": _w((lambda lo, hi, *s: torch.randint(lo, hi, s))(0, N, E).to(torch.int64)),
        "w_msg": _w((lambda *s: torch.randn(*s, dtype=torch.bfloat16) * 0.4)(2 * D + De, D)),
        "w_upd": _w((lambda *s: torch.randn(*s, dtype=torch.bfloat16) * 0.05)(2 * D, D)),
    }

def reference(x, e_attr, src, dst, w_msg, w_upd):
    N, D = x.shape
    m_in = torch.concatenate([x[src], x[dst], e_attr], axis=-1)
    msg = _silu(m_in @ w_msg)
    agg = _segment_sum(msg, dst, N)
    return _silu(torch.concatenate([x, agg], axis=-1) @ w_upd)
```

```asm
; @launch grid=(256,1,1) block=(512,1,1) lds=163840
.amdgcn_target "amdgcn-amd-amdhsa--gfx950"
.text
.globl gather_scatter__mpnn_edge_mlp__graph_kernel
.p2align 8
.type gather_scatter__mpnn_edge_mlp__graph_kernel,@function
gather_scatter__mpnn_edge_mlp__graph_kernel:
    s_cmp_ge_u32 s2, 256
    s_cbranch_scc1 L_end
    s_load_dwordx16 s[4:19], s[0:1], 0
    s_load_dwordx2 s[20:21], s[0:1], 64
    v_lshrrev_b32 v24, 6, v0
    v_and_b32 v1, 63, v0
    v_readfirstlane_b32 s44, v24
    s_sub_u32 s56, s44, 3
    s_cmp_gt_u32 s56, 1
    s_cbranch_scc1 L_nopf
    s_getpc_b64 s[86:87]
L_pc:
    v_and_b32 v42, 127, v0
    v_lshlrev_b32 v42, 7, v42
    v_min_u32 v42, L_codeend-L_pc-4, v42
    global_load_dword v42, v42, s[86:87]
L_nopf:
    v_mov_b32 v120, 0
    v_mov_b32 v121, 0
    v_mov_b32 v122, 0
    v_mov_b32 v123, 0
    v_lshlrev_b32 v32, 4, v0
    ds_write_b128 v32, v[120:123] offset:0
    ds_write_b128 v32, v[120:123] offset:8192
    ds_write_b128 v32, v[120:123] offset:16384
    s_mul_i32 s56, s2, 2500
    v_lshl_add_u32 v40, v0, 2, s56
    s_lshr_b32 s45, s44, 2
    s_and_b32 s46, s44, 3
    v_mov_b32 v28, 0x3fffffff
    v_mov_b32 v29, 0x3fffffff
    v_mov_b32 v30, 0x3fffffff
    v_mov_b32 v31, 0x3fffffff
    v_add_u32 v125, 0x14000, v32
    v_lshrrev_b32 v24, 4, v1
    v_xor_b32 v25, v24, v1
    v_and_b32 v25, 3, v25
    s_lshl_b32 s56, s46, 6
    v_lshl_add_u32 v21, v25, 4, s56
    v_mov_b32 v23, v21
    v_lshrrev_b32 v25, 2, v1
    v_and_b32 v26, 3, v1
    v_lshlrev_b32 v25, 8, v25
    v_lshl_add_u32 v25, v26, 4, v25
    s_lshl_b32 s57, s45, 14
    s_add_u32 s56, s56, s57
    v_add_u32 v13, s56, v25
    s_lshl_b32 s57, s46, 13
    s_lshl_b32 s56, s45, 12
    s_add_u32 s57, s57, s56
    v_cmp_gt_u32 vcc, 113, v0
    s_mov_b64 s[88:89], vcc
    v_lshrrev_b32 v24, 2, v1
    s_lshl_b32 s56, s45, 8
    s_add_u32 s56, s56, s2
    v_lshl_add_u32 v20, v24, 9, s56
    v_add_u32 v22, 0x2000, v20
    s_waitcnt lgkmcnt(0)
    global_load_dword v34, v40, s[10:11]
    global_load_dword v35, v40, s[8:9]
    s_mov_b32 s24, s4
    s_or_b32 s25, s5, 0x1000000
    s_mov_b32 s26, 10000
    s_mov_b32 s27, 0x20000
    s_cmp_ge_u32 s44, 2
    s_cbranch_scc1 L_no2
    s_mov_b64 exec, s[88:89]
    global_load_dword v36, v40, s[10:11] offset:2048
    global_load_dword v37, v40, s[8:9] offset:2048
    s_mov_b64 exec, -1
    s_branch L_nowpf
L_no2:
    s_lshr_b32 s56, s2, 3
    s_cmp_lg_u32 s44, 2
    s_cbranch_scc1 L_noe
    global_load_dword v39, v120, s[20:21] sc1
L_noe:
    s_cmp_lg_u32 s44, 7
    s_cbranch_scc1 L_nw7
    s_lshl_b32 s86, s56, 11
    v_lshl_add_u32 v45, v1, 5, s86
    global_load_dword v45, v45, s[14:15]
L_nw7:
    s_cmp_lg_u32 s44, 6
    s_cbranch_scc1 L_nw6
    s_mul_i32 s86, s56, 2080
    v_lshl_add_u32 v45, v1, 5, s86
    global_load_dword v45, v45, s[12:13] offset:60
L_nw6:
    s_cmp_lg_u32 s44, 5
    s_cbranch_scc1 L_nowpf
    s_mul_i32 s86, s2, 5000
    v_mul_u32_u24 v45, 76, v1
    v_add_u32 v45, s86, v45
    global_load_dword v45, v45, s[6:7] offset:104
L_nowpf:
    s_lshl_b32 s56, s44, 11
    s_add_u32 m0, s56, 0x10000
    s_nop 0
    buffer_load_dwordx4 v[20:21], s[24:27], 0 idxen offen lds
    s_add_u32 m0, s56, 0x10400
    s_nop 0
    buffer_load_dwordx4 v[22:23], s[24:27], 0 idxen offen lds
    ds_write_b128 v125, v[28:31] offset:0
    ds_write_b128 v125, v[28:31] offset:8192
    ds_write_b128 v32, v[120:123] offset:24576
    ds_write_b128 v32, v[120:123] offset:32768
    ds_write_b128 v32, v[120:123] offset:40960
    ds_write_b128 v32, v[120:123] offset:49152
    v_subrev_u32 v33, 32, v0
    v_cmp_gt_u32 vcc, 320, v33
    v_mov_b32 v15, 1
    v_mov_b32 v38, 64012
    v_cndmask_b32_e64 v48, 0, -1, vcc
    v_mov_b32 v49, v48
    v_mov_b32 v50, v48
    v_mov_b32 v51, v48
    v_cmp_gt_u32 vcc, 420, v0
    s_and_b64 exec, vcc, -1
    s_cbranch_execz L_rl_a
    ds_write_b128 v32, v[48:51] offset:57344
L_rl_a:
    s_mov_b64 exec, -1
    s_add_u32 m0, s57, 0x18000
    v_add_u32 v44, 0x0, v13
    global_load_lds_dwordx4 v44, s[12:13]
    s_add_u32 m0, s57, 0x18400
    v_add_u32 v44, 0x1000, v13
    global_load_lds_dwordx4 v44, s[12:13]
    s_add_u32 m0, s57, 0x18800
    v_add_u32 v44, 0x2000, v13
    global_load_lds_dwordx4 v44, s[12:13]
    s_add_u32 m0, s57, 0x18c00
    v_add_u32 v44, 0x3000, v13
    global_load_lds_dwordx4 v44, s[12:13]
    v_lshrrev_b32 v28, 1, v0
    v_and_b32 v29, 1, v0
    v_lshlrev_b32 v29, 4, v29
    v_lshl_add_u32 v43, v28, 6, v29
    v_add_u32 v43, 0x14000, v43
    v_lshlrev_b32 v126, 2, v28
    s_mov_b32 s59, 1808
    s_lshl_b32 s56, s2, 5
    s_add_u32 s56, s56, 0x401000
    v_lshl_add_u32 v47, v28, 13, v29
    v_add_u32 v47, s56, v47
    v_and_b32 v24, 31, v1
    v_lshrrev_b32 v25, 5, v1
    v_bfe_u32 v26, v1, 2, 2
    v_xor_b32 v27, v25, v26
    v_lshlrev_b32 v27, 4, v27
    v_lshl_add_u32 v3, v24, 6, v27
    v_xor_b32 v4, 32, v3
    v_lshlrev_b32 v27, 1, v25
    v_xor_b32 v27, v27, v26
    v_lshlrev_b32 v27, 4, v27
    v_lshl_add_u32 v12, v24, 6, v27
    v_lshl_add_u32 v27, v25, 3, v26
    s_lshl_b32 s56, s46, 13
    v_lshl_add_u32 v27, v27, 6, s56
    v_bfe_u32 v28, v1, 4, 1
    v_and_b32 v29, 3, v1
    v_lshl_add_u32 v30, v28, 2, v29
    v_lshl_add_u32 v5, v30, 3, v27
    v_and_b32 v30, 1, v1
    v_bfe_u32 v31, v1, 1, 1
    v_lshl_add_u32 v33, v28, 1, v31
    v_lshl_add_u32 v41, v30, 2, v33
    v_lshl_add_u32 v6, v41, 3, v27
    v_mov_b32 v14, 7232
    s_mul_i32 s56, s45, 28928
    v_lshl_add_u32 v27, v24, 4, s56
    v_mad_u32_u24 v18, v25, v14, v27
    v_lshl_add_u32 v27, v25, 2, v26
    v_lshl_add_u32 v27, v27, 4, s56
    v_lshl_add_u32 v27, v30, 3, v27
    v_mad_u32_u24 v19, v33, v14, v27
    s_lshl_b32 s56, s46, 6
    v_lshl_add_u32 v16, v24, 1, s56
    s_add_u32 s28, s20, 0x80000
    s_addc_u32 s29, s21, 0
    s_or_b32 s29, s29, 0x1000000
    s_mov_b32 s30, 10000
    s_mov_b32 s31, 0x20000
    s_mov_b32 s32, s6
    s_mov_b32 s33, s7
    s_mov_b32 s34, 1280000
    s_mov_b32 s35, 0x20000
    s_mov_b32 s94, 0xbfb8aa3b
    s_mov_b32 s95, 0xbfb8aa3b
    v_mov_b32 v17, 0x3f80
    s_mov_b32 s96, 0xbf317218
    s_mov_b32 s97, 0xbf317218
    s_mov_b32 s84, 0xaaaaaaaa
    s_mov_b32 s85, 0xaaaaaaaa
    s_lshl_b32 s54, s44, 11
    s_add_u32 s54, s54, 0x10000
    v_add_u32 v7, s54, v3
    v_add_u32 v8, s54, v4
    v_mov_b32 v168, 0
    v_mov_b32 v160, 0
    v_mov_b32 v169, 0
    v_mov_b32 v161, 0
    v_mov_b32 v170, 0
    v_mov_b32 v162, 0
    v_mov_b32 v171, 0
    v_mov_b32 v163, 0
    v_mov_b32 v172, 0
    v_mov_b32 v164, 0
    v_mov_b32 v173, 0
    v_mov_b32 v165, 0
    s_lshl_b32 s56, s2, 13
    s_add_u32 s56, s56, 0x401000
    v_lshl_add_u32 v2, v0, 4, s56
    v_lshrrev_b32 v10, 1, v0
    s_and_b32 s56, s2, 7
    s_lshl_b32 s56, s56, 13
    s_add_u32 s56, s56, 0x10000
    v_lshl_add_u32 v11, v10, 5, s56
    v_mul_u32_u24 v10, 625, v10
    s_mov_b32 s52, 0
    s_mov_b32 s58, 0
    s_mov_b32 s51, 0
    s_mov_b64 s[72:73], -1
    v_add_u32 v9, 0x201000, v2
    s_and_b32 s56, s2, 7
    s_lshl_b32 s56, s56, 5
    s_lshr_b32 s86, s2, 3
    s_add_u32 s56, s56, s86
    s_lshl_b32 s56, s56, 5
    s_add_u32 s56, s56, 0x10000
    v_lshl_add_u32 v124, v1, 13, s56
    s_and_b32 s56, s2, 0xf8
    s_lshr_b32 s86, s56, 2
    s_lshl_b64 s[92:93], 1, s86
    s_add_u32 s56, s56, s44
    v_lshl_add_u32 v175, v1, 8, s56
    s_mov_b32 s55, 0x14000
    s_lshl_b32 s56, s45, 13
    s_add_u32 s56, s56, 0x10000
    v_add_u32 v128, s56, v3
    v_add_u32 v129, s56, v4
    v_add_u32 v130, 0x18000, v6
    s_add_u32 s56, s54, 0xffff4000
    v_add_u32 v26, s56, v12
    v_xor_b32 v27, 16, v26
    v_lshl_add_u32 v40, v1, 4, s56
    s_waitcnt vmcnt(6)
    v_and_b32 v32, 255, v34
    v_lshlrev_b32 v30, 2, v32
    v_lshl_add_u32 v32, v32, 6, s55
    v_and_b32 v33, 255, v36
    v_lshlrev_b32 v31, 2, v33
    v_lshl_add_u32 v33, v33, 6, s55
    v_bfe_u32 v24, v34, 9, 5
    v_and_b32 v28, 0x13, v24
    v_and_b32 v25, 4, v24
    v_lshl_or_b32 v28, v25, 1, v28
    v_bfe_u32 v25, v24, 3, 1
    v_lshl_or_b32 v28, v25, 2, v28
    v_bfe_u32 v25, v34, 8, 1
    v_lshl_or_b32 v28, v25, 5, v28
    v_and_b32 v25, 0x3fff, v35
    v_lshl_or_b32 v28, v28, 14, v25
    v_lshl_or_b32 v28, v0, 20, v28
    s_cmp_ge_u32 s44, 2
    s_cbranch_scc1 L_mr2
    v_bfe_u32 v24, v36, 9, 5
    v_and_b32 v29, 0x13, v24
    v_and_b32 v25, 4, v24
    v_lshl_or_b32 v29, v25, 1, v29
    v_bfe_u32 v25, v24, 3, 1
    v_lshl_or_b32 v29, v25, 2, v29
    v_bfe_u32 v25, v36, 8, 1
    v_lshl_or_b32 v29, v25, 5, v29
    v_and_b32 v25, 0x3fff, v37
    v_lshl_or_b32 v29, v29, 14, v25
    v_add_u32 v24, 512, v0
    v_lshl_or_b32 v29, v24, 20, v29
L_mr2:
    s_lshl_b32 s56, s44, 7
    v_lshl_add_u32 v41, v1, 4, s56
    v_add_u32 v41, 0x10000, v41
    s_add_u32 m0, s56, 64512
    s_mov_b64 exec, 0xff
    global_load_lds_dwordx4 v41, s[12:13]
    s_mov_b64 exec, -1
    s_add_u32 m0, s57, 0x20000
    v_add_u32 v44, 0x8000, v13
    global_load_lds_dwordx4 v44, s[12:13]
    s_add_u32 m0, s57, 0x20400
    v_add_u32 v44, 0x9000, v13
    global_load_lds_dwordx4 v44, s[12:13]
    s_add_u32 m0, s57, 0x20800
    v_add_u32 v44, 0xa000, v13
    global_load_lds_dwordx4 v44, s[12:13]
    s_add_u32 m0, s57, 0x20c00
    v_add_u32 v44, 0xb000, v13
    global_load_lds_dwordx4 v44, s[12:13]
    s_waitcnt vmcnt(5) lgkmcnt(0)
    s_barrier
    ds_read_b128 v[208:211], v128 offset:0
    ds_read_b64_tr_b16 v[176:177], v130 offset:0
    ds_read_b64_tr_b16 v[178:179], v130 offset:256
    ds_read_b128 v[212:215], v129 offset:0
    ds_read_b64_tr_b16 v[180:181], v130 offset:1024
    ds_read_b64_tr_b16 v[182:183], v130 offset:1280
    ds_read_b128 v[216:219], v128 offset:2048
    ds_read_b64_tr_b16 v[184:185], v130 offset:2048
    ds_read_b64_tr_b16 v[186:187], v130 offset:2304
    ds_read_b128 v[220:223], v129 offset:2048
    ds_read_b64_tr_b16 v[188:189], v130 offset:3072
    ds_read_b64_tr_b16 v[190:191], v130 offset:3328
    ds_read_b128 v[224:227], v128 offset:4096
    ds_read_b64_tr_b16 v[192:193], v130 offset:4096
    ds_read_b64_tr_b16 v[194:195], v130 offset:4352
    s_waitcnt lgkmcnt(12)
    v_mfma_f32_32x32x16_bf16 v[80:95], v[176:179], v[208:211], 0
    ds_read_b128 v[228:231], v129 offset:4096
    ds_read_b64_tr_b16 v[196:197], v130 offset:5120
    ds_read_b64_tr_b16 v[198:199], v130 offset:5376
    s_waitcnt lgkmcnt(12)
    v_mfma_f32_32x32x16_bf16 v[80:95], v[180:183], v[212:215], v[80:95]
    ds_read_b128 v[232:235], v128 offset:6144
    ds_read_b64_tr_b16 v[200:201], v130 offset:6144
    ds_read_b64_tr_b16 v[202:203], v130 offset:6400
    s_waitcnt lgkmcnt(12)
    v_mfma_f32_32x32x16_bf16 v[80:95], v[184:187], v[216:219], v[80:95]
    ds_read_b128 v[236:239], v129 offset:6144
    ds_read_b64_tr_b16 v[204:205], v130 offset:7168
    ds_read_b64_tr_b16 v[206:207], v130 offset:7424
    ds_add_rtn_u32 v30, v30, v15 offset:62976
    s_waitcnt lgkmcnt(13)
    v_mfma_f32_32x32x16_bf16 v[80:95], v[188:191], v[220:223], v[80:95]
    s_waitcnt lgkmcnt(10)
    v_mfma_f32_32x32x16_bf16 v[80:95], v[192:195], v[224:227], v[80:95]
    s_waitcnt lgkmcnt(7)
    v_mfma_f32_32x32x16_bf16 v[80:95], v[196:199], v[228:231], v[80:95]
    s_waitcnt lgkmcnt(4)
    v_mfma_f32_32x32x16_bf16 v[80:95], v[200:203], v[232:235], v[80:95]
    s_waitcnt lgkmcnt(1)
    v_mfma_f32_32x32x16_bf16 v[80:95], v[204:207], v[236:239], v[80:95]
    s_waitcnt lgkmcnt(0)
    s_cmp_ge_u32 s44, 2
    s_cbranch_scc1 L_rk2
    s_mov_b64 exec, s[88:89]
    ds_add_rtn_u32 v31, v31, v15 offset:62976
    s_mov_b64 exec, -1
L_rk2:
    v_cmp_gt_u32 vcc, 12, v30
    v_mul_u32_u24 v24, 11, v30
    v_lshrrev_b32 v24, 5, v24
    v_add_u32 v24, v24, v30
    v_lshl_add_u32 v24, v24, 2, v32
    s_andn2_b64 s[86:87], exec, vcc
    s_cbranch_scc1 L_putx32
L_putr32:
    ds_write_b32 v24, v28
    s_mov_b64 exec, -1
    s_nop 2
    v_pk_mul_f32 v[80:81], v[80:81], s[94:95]
    v_pk_mul_f32 v[82:83], v[82:83], s[94:95]
    v_pk_mul_f32 v[84:85], v[84:85], s[94:95]
    v_pk_mul_f32 v[86:87], v[86:87], s[94:95]
    v_pk_mul_f32 v[88:89], v[88:89], s[94:95]
    v_pk_mul_f32 v[90:91], v[90:91], s[94:95]
    v_pk_mul_f32 v[92:93], v[92:93], s[94:95]
    v_pk_mul_f32 v[94:95], v[94:95], s[94:95]
    v_cvt_pk_bf16_f32 v96, v80, v81
    v_cvt_pk_bf16_f32 v97, v82, v83
    v_cvt_pk_bf16_f32 v98, v84, v85
    v_cvt_pk_bf16_f32 v99, v86, v87
    v_cvt_pk_bf16_f32 v100, v88, v89
    v_cvt_pk_bf16_f32 v101, v90, v91
    v_cvt_pk_bf16_f32 v102, v92, v93
    v_cvt_pk_bf16_f32 v103, v94, v95
    ds_write_b128 v26, v[96:99]
    ds_write_b128 v27, v[100:103]
    ds_read_b128 v[96:99], v40
    ds_read_b128 v[100:103], v40 offset:1024
    s_waitcnt lgkmcnt(1)
    buffer_store_dwordx4 v[96:99], v[20:21], s[28:31], 0 idxen offen sc1
    s_waitcnt lgkmcnt(0)
    buffer_store_dwordx4 v[100:103], v[22:23], s[28:31], 0 idxen offen sc1
    ds_write_b128 v26, v[120:123]
    ds_write_b128 v27, v[120:123]
    s_cmp_gt_u32 s44, 2
    s_cbranch_scc1 L_rk3
    s_cmp_eq_u32 s44, 2
    s_cbranch_scc1 L_rk4
    s_mov_b64 exec, s[88:89]
    v_cmp_gt_u32 vcc, 12, v31
    v_mul_u32_u24 v24, 11, v31
    v_lshrrev_b32 v24, 5, v24
    v_add_u32 v24, v24, v31
    v_lshl_add_u32 v24, v24, 2, v33
    s_andn2_b64 s[86:87], exec, vcc
    s_cbranch_scc1 L_putx33
L_putr33:
    ds_write_b32 v24, v29
    s_mov_b64 exec, -1
    s_branch L_rk3
L_rk4:
    ds_write_b32 v38, v39
L_rk3:
    v_add_u32 v39, 0x201000, v47
    s_waitcnt vmcnt(2) lgkmcnt(0)
    s_barrier
    ds_read_b32 v33, v38
    ds_read_b128 v[24:27], v43
    ds_read_b32 v37, v126 offset:62976
    ds_read_b128 v[28:31], v43 offset:32
    s_waitcnt lgkmcnt(3)
    v_readfirstlane_b32 s48, v33
    s_add_u32 s48, s48, 1
    s_mul_i32 s47, s48, 0x9e3779b1
    s_waitcnt lgkmcnt(2)
    v_mov_b32 v27, s47
    global_store_dwordx4 v47, v[24:27], s[20:21] sc1
    s_waitcnt lgkmcnt(0)
    v_cmp_le_u32 vcc, 6, v37
    v_mov_b32 v31, s47
    s_and_b64 exec, vcc, -1
    s_cbranch_execz L_pub1
    v_cmp_le_u32 vcc, 13, v37
    s_mov_b32 s52, 1
    s_cbranch_vccnz L_pub_more
L_pub_b:
    global_store_dwordx4 v39, v[28:31], s[20:21] sc1
L_pub1:
    s_mov_b64 exec, -1
    v_add_u32 v44, 0x20000, v5
    ds_read_b64_tr_b16 v[48:49], v44 offset:0
    ds_read_b64_tr_b16 v[50:51], v44 offset:256
    ds_read_b64_tr_b16 v[52:53], v44 offset:1024
    ds_read_b64_tr_b16 v[54:55], v44 offset:1280
    ds_read_b64_tr_b16 v[56:57], v44 offset:2048
    ds_read_b64_tr_b16 v[58:59], v44 offset:2304
    ds_read_b64_tr_b16 v[60:61], v44 offset:3072
    ds_read_b64_tr_b16 v[62:63], v44 offset:3328
    ds_read_b64_tr_b16 v[64:65], v44 offset:4096
    ds_read_b64_tr_b16 v[66:67], v44 offset:4352
    ds_read_b64_tr_b16 v[68:69], v44 offset:5120
    ds_read_b64_tr_b16 v[70:71], v44 offset:5376
    ds_read_b64_tr_b16 v[72:73], v44 offset:6144
    ds_read_b64_tr_b16 v[74:75], v44 offset:6400
    ds_read_b64_tr_b16 v[76:77], v44 offset:7168
    ds_read_b64_tr_b16 v[78:79], v44 offset:7424
    ds_read_u16_d16_hi v120, v16 offset:64512
    ds_read_u16_d16_hi v121, v16 offset:64768
    ds_read_u16_d16_hi v122, v16 offset:65024
    ds_read_u16_d16_hi v123, v16 offset:65280
    s_waitcnt lgkmcnt(15)
    v_mfma_f32_32x32x16_bf16 v[104:119], v[208:211], v[48:51], 0
    s_waitcnt lgkmcnt(15)
    v_mfma_f32_32x32x16_bf16 v[104:119], v[212:215], v[52:55], v[104:119]
    s_waitcnt lgkmcnt(14)
    v_mfma_f32_32x32x16_bf16 v[104:119], v[216:219], v[56:59], v[104:119]
    s_waitcnt lgkmcnt(12)
    v_mfma_f32_32x32x16_bf16 v[104:119], v[220:223], v[60:63], v[104:119]
    s_waitcnt lgkmcnt(10)
    v_mfma_f32_32x32x16_bf16 v[104:119], v[224:227], v[64:67], v[104:119]
    s_waitcnt lgkmcnt(8)
    v_mfma_f32_32x32x16_bf16 v[104:119], v[228:231], v[68:71], v[104:119]
    s_waitcnt lgkmcnt(6)
    v_mfma_f32_32x32x16_bf16 v[104:119], v[232:235], v[72:75], v[104:119]
    s_waitcnt lgkmcnt(4)
    v_mfma_f32_32x32x16_bf16 v[104:119], v[236:239], v[76:79], v[104:119]
    v_and_b32 v34, 31, v1
    v_lshrrev_b32 v35, 5, v1
    v_lshlrev_b32 v35, 3, v35
    v_sub_u32 v34, v34, v35
    v_and_b32 v35, 1, v1
    v_lshlrev_b32 v35, 4, v35
    v_lshlrev_b32 v35, v35, v17
    v_ashrrev_i32 v34, 1, v34
    v_cmp_eq_u32 vcc, 0, v34
    s_nop 1
    v_cndmask_b32_e64 v144, 0, v35, vcc
    v_cmp_eq_u32 vcc, 1, v34
    s_nop 1
    v_cndmask_b32_e64 v145, 0, v35, vcc
    v_cmp_eq_u32 vcc, 2, v34
    s_nop 1
    v_cndmask_b32_e64 v146, 0, v35, vcc
    v_cmp_eq_u32 vcc, 3, v34
    s_nop 1
    v_cndmask_b32_e64 v147, 0, v35, vcc
    v_cmp_eq_u32 vcc, 8, v34
    s_nop 1
    v_cndmask_b32_e64 v148, 0, v35, vcc
    v_cmp_eq_u32 vcc, 9, v34
    s_nop 1
    v_cndmask_b32_e64 v149, 0, v35, vcc
    v_cmp_eq_u32 vcc, 10, v34
    s_nop 1
    v_cndmask_b32_e64 v150, 0, v35, vcc
    v_cmp_eq_u32 vcc, 11, v34
    s_nop 1
    v_cndmask_b32_e64 v151, 0, v35, vcc
    s_waitcnt lgkmcnt(0)
    s_mov_b32 exec_lo, 0
    v_mov_b32 v112, v120
    v_mov_b32 v113, v121
    v_mov_b32 v114, v122
    v_mov_b32 v115, v123
    s_mov_b32 exec_lo, -1
    v_pk_mul_f32 v[104:105], v[104:105], s[94:95]
    v_pk_mul_f32 v[106:107], v[106:107], s[94:95]
    v_pk_mul_f32 v[108:109], v[108:109], s[94:95]
    v_pk_mul_f32 v[110:111], v[110:111], s[94:95]
    v_pk_mul_f32 v[112:113], v[112:113], s[94:95]
    v_pk_mul_f32 v[114:115], v[114:115], s[94:95]
    v_pk_mul_f32 v[116:117], v[116:117], s[94:95]
    v_pk_mul_f32 v[118:119], v[118:119], s[94:95]
    v_cvt_pk_bf16_f32 v136, v104, v105
    v_cvt_pk_bf16_f32 v137, v106, v107
    v_cvt_pk_bf16_f32 v138, v108, v109
    v_cvt_pk_bf16_f32 v139, v110, v111
    v_cvt_pk_bf16_f32 v140, v112, v113
    v_cvt_pk_bf16_f32 v141, v114, v115
    v_cvt_pk_bf16_f32 v142, v116, v117
    v_cvt_pk_bf16_f32 v143, v118, v119
    v_mov_b32 v104, 0
    v_mov_b32 v105, 0
    v_mov_b32 v106, 0
    v_mov_b32 v107, 0
    v_mov_b32 v108, 0
    v_mov_b32 v109, 0
    v_mov_b32 v110, 0
    v_mov_b32 v111, 0
    v_mov_b32 v112, 0
    v_mov_b32 v113, 0
    v_mov_b32 v114, 0
    v_mov_b32 v115, 0
    v_mov_b32 v116, 0
    v_mov_b32 v117, 0
    v_mov_b32 v118, 0
    v_mov_b32 v119, 0
    v_mov_b32 v24, s47
    v_not_b32 v25, v24
    s_cmp_gt_u32 s52, 1
    s_cbranch_scc1 L_pw4
    s_cmp_eq_u32 s52, 1
    s_cbranch_scc1 L_pw2
    s_waitcnt vmcnt(1)
L_pw2:
    s_waitcnt vmcnt(2)
L_pw4:
    s_waitcnt vmcnt(4)
    s_mov_b32 s52, 0
    s_barrier
    s_cmp_lg_u32 s44, 0
    s_cbranch_scc1 L_noflag
    s_mov_b64 exec, 0xff
    global_store_dwordx2 v124, v[24:25], s[20:21] sc1
    s_mov_b64 exec, -1
L_noflag:
    s_add_u32 m0, s57, 0x20000
    v_add_u32 v44, 0x0, v13
    global_load_lds_dwordx4 v44, s[14:15]
    s_add_u32 m0, s57, 0x20400
    v_add_u32 v44, 0x1000, v13
    global_load_lds_dwordx4 v44, s[14:15]
    s_add_u32 m0, s57, 0x20800
    v_add_u32 v44, 0x2000, v13
    global_load_lds_dwordx4 v44, s[14:15]
    s_add_u32 m0, s57, 0x20c00
    v_add_u32 v44, 0x3000, v13
    global_load_lds_dwordx4 v44, s[14:15]
    global_load_dwordx4 v[152:155], v2, s[20:21] sc1
    global_load_dwordx4 v[156:159], v9, s[20:21] sc1
    s_waitcnt vmcnt(0)
    s_branch L_pollD
L_level:
    s_mov_b64 s[80:81], s[72:73]
    s_mov_b64 s[82:83], s[72:73]
    v_add_u32 v9, 0x201000, v2
L_poll:
    s_mov_b64 exec, s[80:81]
    s_cbranch_execz L_pollB
    global_load_dwordx4 v[152:155], v2, s[20:21] sc1
L_pollB:
    s_mov_b64 exec, s[82:83]
    s_cbranch_execz L_pollC
    global_load_dwordx4 v[156:159], v9, s[20:21] sc1
L_pollC:
    s_mov_b64 exec, s[72:73]
    s_add_u32 s58, s58, 1
    s_waitcnt vmcnt(0)
L_pollD:
    v_or3_b32 v24, v152, v153, v154
    v_or3_b32 v25, v156, v157, v158
    v_cmp_eq_u32 s[74:75], s47, v155
    v_cmp_eq_u32 s[76:77], s47, v159
    v_cmp_gt_u32 s[80:81], 2.0, v24
    v_cmp_le_i32 s[82:83], 0, v25
    v_cmp_ne_u32 vcc, 0x3fffffff, v154
    s_and_b64 s[74:75], s[74:75], s[80:81]
    s_and_b64 s[76:77], s[76:77], s[82:83]
    s_and_b64 s[78:79], vcc, s[74:75]
    s_and_b64 s[78:79], s[78:79], s[84:85]
    s_lshr_b64 s[86:87], s[78:79], 1
    s_or_b64 s[78:79], s[78:79], s[86:87]
    s_andn2_b64 s[80:81], s[72:73], s[74:75]
    s_and_b64 s[86:87], s[80:81], s[84:85]
    s_or_b64 s[82:83], s[78:79], s[86:87]
    s_lshr_b64 s[86:87], s[86:87], 1
    s_or_b64 s[82:83], s[82:83], s[86:87]
    s_andn2_b64 s[82:83], s[82:83], s[76:77]
    s_or_b64 s[86:87], s[80:81], s[82:83]
    s_cbranch_scc0 L_got
    s_cmp_lt_u32 s58, 2000
    s_cbranch_scc1 L_poll
    s_branch L_timeout
L_got:
    s_mov_b64 exec, -1
    global_load_dwordx2 v[38:39], v11, s[20:21] sc1
    v_cmp_ne_u32 vcc, 0x3fffffff, v152
    s_and_b64 s[60:61], vcc, s[72:73]
    v_cmp_ne_u32 vcc, 0x3fffffff, v153
    s_and_b64 s[62:63], vcc, s[72:73]
    v_cmp_ne_u32 vcc, 0x3fffffff, v154
    s_and_b64 s[64:65], vcc, s[72:73]
    v_cmp_ne_u32 vcc, 0x3fffffff, v156
    s_and_b64 s[66:67], vcc, s[78:79]
    v_cmp_ne_u32 vcc, 0x3fffffff, v157
    s_and_b64 s[68:69], vcc, s[78:79]
    v_cmp_ne_u32 vcc, 0x3fffffff, v158
    s_and_b64 s[70:71], vcc, s[78:79]
    v_mov_b32 v32, 0
    s_mov_b64 exec, s[60:61]
    s_cbranch_execz L_ra2
    v_bfe_u32 v168, v152, 20, 10
    v_add_lshl_u32 v168, v168, v10, 3
    v_bfe_u32 v26, v152, 19, 1
    v_mov_b32 v160, v32
    v_lshlrev_b32 v26, 4, v26
    v_lshl_add_u32 v32, v15, v26, v32
    s_mov_b64 exec, s[62:63]
    s_cbranch_execz L_ra2
    v_bfe_u32 v169, v153, 20, 10
    v_add_lshl_u32 v169, v169, v10, 3
    v_bfe_u32 v27, v153, 19, 1
    v_mov_b32 v161, v32
    v_lshlrev_b32 v27, 4, v27
    v_lshl_add_u32 v32, v15, v27, v32
    s_mov_b64 exec, s[64:65]
    s_cbranch_execz L_ra2
    v_bfe_u32 v170, v154, 20, 10
    v_add_lshl_u32 v170, v170, v10, 3
    v_bfe_u32 v28, v154, 19, 1
    v_mov_b32 v162, v32
    v_lshlrev_b32 v28, 4, v28
    v_lshl_add_u32 v32, v15, v28, v32
L_ra2:
    s_mov_b64 exec, s[66:67]
    s_cbranch_execz L_ra5
    v_bfe_u32 v171, v156, 20, 10
    v_add_lshl_u32 v171, v171, v10, 3
    v_bfe_u32 v29, v156, 19, 1
    v_mov_b32 v163, v32
    v_lshlrev_b32 v29, 4, v29
    v_lshl_add_u32 v32, v15, v29, v32
    s_mov_b64 exec, s[68:69]
    s_cbranch_execz L_ra5
    v_bfe_u32 v172, v157, 20, 10
    v_add_lshl_u32 v172, v172, v10, 3
    v_bfe_u32 v30, v157, 19, 1
    v_mov_b32 v164, v32
    v_lshlrev_b32 v30, 4, v30
    v_lshl_add_u32 v32, v15, v30, v32
    s_mov_b64 exec, s[70:71]
    s_cbranch_execz L_ra5
    v_bfe_u32 v173, v158, 20, 10
    v_add_lshl_u32 v173, v173, v10, 3
    v_bfe_u32 v31, v158, 19, 1
    v_mov_b32 v165, v32
    v_lshlrev_b32 v31, 4, v31
    v_lshl_add_u32 v32, v15, v31, v32
L_ra5:
    s_mov_b64 exec, -1
    v_mov_b32 v24, 64000
    s_nop 0
    v_add_u32_dpp v33, v32, v32 row_shr:1 row_mask:0xf bank_mask:0xf bound_ctrl:0
    s_nop 1
    v_add_u32_dpp v33, v33, v33 row_shr:2 row_mask:0xf bank_mask:0xf bound_ctrl:0
    s_nop 1
    v_add_u32_dpp v33, v33, v33 row_shr:4 row_mask:0xf bank_mask:0xf bound_ctrl:0
    s_nop 1
    v_add_u32_dpp v33, v33, v33 row_shr:8 row_mask:0xf bank_mask:0xf bound_ctrl:0
    s_nop 1
    v_add_u32_dpp v33, v33, v33 row_bcast:15 row_mask:0xa bank_mask:0xf
    s_nop 1
    v_add_u32_dpp v33, v33, v33 row_bcast:31 row_mask:0xc bank_mask:0xf
    s_mov_b32 exec_lo, 0
    s_mov_b32 exec_hi, 0x80000000
    v_and_b32 v34, 0xffff, v33
    v_lshrrev_b32 v35, 16, v33
    ds_add_rtn_u64 v[34:35], v24, v[34:35]
    s_mov_b64 exec, s[60:61]
    buffer_load_dwordx2 v[80:81], v168, s[32:35], 0 offen
    s_mov_b64 exec, s[62:63]
    buffer_load_dwordx2 v[82:83], v169, s[32:35], 0 offen
    s_mov_b64 exec, s[64:65]
    buffer_load_dwordx2 v[84:85], v170, s[32:35], 0 offen
L_re2:
    s_mov_b64 exec, s[66:67]
    buffer_load_dwordx2 v[86:87], v171, s[32:35], 0 offen
    s_mov_b64 exec, s[68:69]
    buffer_load_dwordx2 v[88:89], v172, s[32:35], 0 offen
    s_mov_b64 exec, s[70:71]
    buffer_load_dwordx2 v[90:91], v173, s[32:35], 0 offen
L_re5:
    s_mov_b64 exec, -1
    v_sub_u32 v33, v33, v32
    global_load_dwordx2 v[46:47], v11, s[20:21] sc1
    v_cmp_le_u32 vcc, 2.0, v158
    s_and_b64 s[72:73], s[70:71], s[84:85]
    s_and_b64 s[72:73], s[72:73], vcc
    s_waitcnt lgkmcnt(0)
    v_lshl_or_b32 v34, v35, 16, v34
    s_nop 0
    v_readlane_b32 s56, v34, 63
    s_nop 1
    v_add_u32 v33, s56, v33
    s_mov_b64 exec, s[60:61]
    s_cbranch_execz L_rb2
    v_add_u32 v160, v160, v33
    v_bfe_u32 v160, v160, v26, 16
    v_cmp_gt_u32 vcc, 448, v160
    s_and_b64 exec, exec, vcc
    s_mov_b64 s[60:61], exec
    v_mul_u32_u24 v25, 160, v26
    v_lshl_add_u32 v25, v160, 2, v25
    v_lshlrev_b32 v160, 4, v160
    v_and_b32 v16, 0x3fff, v152
    ds_write_b32 v25, v16 offset:57856
    v_bfe_u32 v25, v152, 17, 3
    v_mad_u32_u24 v25, v25, v14, v160
    v_bfe_u32 v16, v152, 14, 3
    v_lshl_add_u32 v25, v16, 1, v25
    ds_write_b16 v25, v17
    v_mad_u32_u24 v160, v26, s59, v160
    s_mov_b64 exec, s[62:63]
    s_cbranch_execz L_rb2
    v_add_u32 v161, v161, v33
    v_bfe_u32 v161, v161, v27, 16
    v_cmp_gt_u32 vcc, 448, v161
    s_and_b64 exec, exec, vcc
    s_mov_b64 s[62:63], exec
    v_mul_u32_u24 v25, 160, v27
    v_lshl_add_u32 v25, v161, 2, v25
    v_lshlrev_b32 v161, 4, v161
    v_and_b32 v16, 0x3fff, v153
    ds_write_b32 v25, v16 offset:57856
    v_bfe_u32 v25, v153, 17, 3
    v_mad_u32_u24 v25, v25, v14, v161
    v_bfe_u32 v16, v153, 14, 3
    v_lshl_add_u32 v25, v16, 1, v25
    ds_write_b16 v25, v17
    v_mad_u32_u24 v161, v27, s59, v161
    s_mov_b64 exec, s[64:65]
    s_cbranch_execz L_rb2
    v_add_u32 v162, v162, v33
    v_bfe_u32 v162, v162, v28, 16
    v_cmp_gt_u32 vcc, 448, v162
    s_and_b64 exec, exec, vcc
    s_mov_b64 s[64:65], exec
    v_mul_u32_u24 v25, 160, v28
    v_lshl_add_u32 v25, v162, 2, v25
    v_lshlrev_b32 v162, 4, v162
    v_and_b32 v16, 0x3fff, v154
    ds_write_b32 v25, v16 offset:57856
    v_bfe_u32 v25, v154, 17, 3
    v_mad_u32_u24 v25, v25, v14, v162
    v_bfe_u32 v16, v154, 14, 3
    v_lshl_add_u32 v25, v16, 1, v25
    ds_write_b16 v25, v17
    v_mad_u32_u24 v162, v28, s59, v162
L_rb2:
    s_mov_b64 exec, s[66:67]
    s_cbranch_execz L_rb5
    v_add_u32 v163, v163, v33
    v_bfe_u32 v163, v163, v29, 16
    v_cmp_gt_u32 vcc, 448, v163
    s_and_b64 exec, exec, vcc
    s_mov_b64 s[66:67], exec
    v_mul_u32_u24 v25, 160, v29
    v_lshl_add_u32 v25, v163, 2, v25
    v_lshlrev_b32 v163, 4, v163
    v_and_b32 v16, 0x3fff, v156
    ds_write_b32 v25, v16 offset:57856
    v_bfe_u32 v25, v156, 17, 3
    v_mad_u32_u24 v25, v25, v14, v163
    v_bfe_u32 v16, v156, 14, 3
    v_lshl_add_u32 v25, v16, 1, v25
    ds_write_b16 v25, v17
    v_mad_u32_u24 v163, v29, s59, v163
    s_mov_b64 exec, s[68:69]
    s_cbranch_execz L_rb5
    v_add_u32 v164, v164, v33
    v_bfe_u32 v164, v164, v30, 16
    v_cmp_gt_u32 vcc, 448, v164
    s_and_b64 exec, exec, vcc
    s_mov_b64 s[68:69], exec
    v_mul_u32_u24 v25, 160, v30
    v_lshl_add_u32 v25, v164, 2, v25
    v_lshlrev_b32 v164, 4, v164
    v_and_b32 v16, 0x3fff, v157
    ds_write_b32 v25, v16 offset:57856
    v_bfe_u32 v25, v157, 17, 3
    v_mad_u32_u24 v25, v25, v14, v164
    v_bfe_u32 v16, v157, 14, 3
    v_lshl_add_u32 v25, v16, 1, v25
    ds_write_b16 v25, v17
    v_mad_u32_u24 v164, v30, s59, v164
    s_mov_b64 exec, s[70:71]
    s_cbranch_execz L_rb5
    v_add_u32 v165, v165, v33
    v_bfe_u32 v165, v165, v31, 16
    v_cmp_gt_u32 vcc, 448, v165
    s_and_b64 exec, exec, vcc
    s_mov_b64 s[70:71], exec
    v_mul_u32_u24 v25, 160, v31
    v_lshl_add_u32 v25, v165, 2, v25
    v_lshlrev_b32 v165, 4, v165
    v_and_b32 v16, 0x3fff, v158
    ds_write_b32 v25, v16 offset:57856
    v_bfe_u32 v25, v158, 17, 3
    v_mad_u32_u24 v25, v25, v14, v165
    v_bfe_u32 v16, v158, 14, 3
    v_lshl_add_u32 v25, v16, 1, v25
    ds_write_b16 v25, v17
    v_mad_u32_u24 v165, v31, s59, v165
L_rb5:
    s_mov_b64 exec, -1
    s_cmp_lg_u64 s[72:73], 0
    s_cbranch_scc1 L_nextlevel
    s_mov_b64 s[90:91], -1
    s_waitcnt vmcnt(7)
    s_mov_b64 exec, s[90:91]
    v_not_b32 v39, v39
    v_cmp_ne_u32 vcc, s47, v38
    v_cmp_ne_u32 s[86:87], s47, v39
    s_or_b64 s[90:91], vcc, s[86:87]
    s_mov_b64 exec, -1
    s_mov_b64 exec, s[90:91]
    s_cbranch_execz L_flagsok
L_flags:
    s_waitcnt vmcnt(0)
    s_mov_b64 exec, s[90:91]
    v_not_b32 v47, v47
    v_cmp_ne_u32 vcc, s47, v46
    v_cmp_ne_u32 s[86:87], s47, v47
    s_or_b64 s[90:91], vcc, s[86:87]
    s_mov_b64 exec, -1
    s_mov_b64 exec, s[90:91]
    s_cbranch_execz L_flagsok
    global_load_dwordx2 v[46:47], v11, s[20:21] sc1
    s_add_u32 s58, s58, 1
    s_cmp_lt_u32 s58, 2000
    s_cbranch_scc1 L_flags
L_timeout:
    s_mov_b32 s51, 2
L_setmode:
    s_mov_b64 exec, -1
    s_waitcnt vmcnt(0)
    v_mov_b32 v24, 64008
    v_mov_b32 v25, s51
    ds_max_u32 v24, v25
    s_branch L_barE
L_flagsok:
    s_mov_b64 exec, -1
    s_cmp_lg_u32 s51, 0
    s_cbranch_scc1 L_setmode
L_barE:
    s_mul_i32 s56, s45, 2560
    s_add_u32 s56, s56, 57856
    v_and_b32 v11, 60, v1
    v_add_u32 v11, s56, v11
    v_mov_b32 v24, 64000
    s_waitcnt lgkmcnt(0)
    s_barrier
    ds_read_b96 v[28:30], v24
    ds_read2_b32 v[36:37], v11 offset0:0 offset1:16
    ds_read2_b32 v[38:39], v11 offset0:32 offset1:48
    ds_read2_b32 v[40:41], v11 offset0:64 offset1:80
    ds_read2_b32 v[42:43], v11 offset0:96 offset1:112
    s_waitcnt lgkmcnt(4)
    v_max_u32 v31, v28, v29
    v_readfirstlane_b32 s51, v30
    v_readfirstlane_b32 s56, v31
    s_cmp_gt_u32 s56, 448
    s_cselect_b32 s56, 1, 0
    s_max_u32 s51, s51, s56
    s_cmp_lg_u32 s51, 0
    s_cbranch_scc1 L_slow
    s_mov_b32 s55, 0
L_flush2:
    v_readfirstlane_b32 s49, v28
    v_readfirstlane_b32 s56, v29
    s_cmp_lg_u32 s45, 0
    s_cselect_b32 s49, s56, s49
    s_min_u32 s49, s49, 448
    s_add_u32 s49, s49, 31
    s_lshr_b32 s49, s49, 5
    v_mov_b32 v9, v18
    v_mov_b32 v10, v19
    s_waitcnt lgkmcnt(3)
    v_mov_b32 v20, v36
    v_mov_b32 v22, v37
    s_mov_b32 m0, s54
    s_nop 0
    buffer_load_dwordx4 v[20:21], s[28:31], 0 idxen offen lds
    s_add_u32 m0, s54, 0x400
    s_nop 0
    buffer_load_dwordx4 v[22:23], s[28:31], 0 idxen offen lds
    s_waitcnt lgkmcnt(2)
    v_mov_b32 v20, v38
    v_mov_b32 v22, v39
    s_add_u32 m0, s54, 0x4000
    s_nop 0
    buffer_load_dwordx4 v[20:21], s[28:31], 0 idxen offen lds
    s_add_u32 m0, s54, 0x4400
    s_nop 0
    buffer_load_dwordx4 v[22:23], s[28:31], 0 idxen offen lds
    s_cmp_lg_u32 s51, 0
    s_cbranch_scc1 L_nou
    v_add_u32 v44, 0x20000, v6
    ds_read_b64_tr_b16 v[48:49], v44 offset:0
    ds_read_b64_tr_b16 v[50:51], v44 offset:256
    ds_read_b64_tr_b16 v[52:53], v44 offset:1024
    ds_read_b64_tr_b16 v[54:55], v44 offset:1280
    ds_read_b64_tr_b16 v[56:57], v44 offset:2048
    ds_read_b64_tr_b16 v[58:59], v44 offset:2304
    ds_read_b64_tr_b16 v[60:61], v44 offset:3072
    ds_read_b64_tr_b16 v[62:63], v44 offset:3328
    ds_read_b64_tr_b16 v[64:65], v44 offset:4096
    ds_read_b64_tr_b16 v[66:67], v44 offset:4352
    ds_read_b64_tr_b16 v[68:69], v44 offset:5120
    ds_read_b64_tr_b16 v[70:71], v44 offset:5376
    ds_read_b64_tr_b16 v[72:73], v44 offset:6144
    ds_read_b64_tr_b16 v[74:75], v44 offset:6400
    ds_read_b64_tr_b16 v[76:77], v44 offset:7168
    ds_read_b64_tr_b16 v[78:79], v44 offset:7424
    s_waitcnt lgkmcnt(14)
    v_mfma_f32_32x32x16_bf16 v[120:135], v[48:51], v[208:211], 0
    s_waitcnt lgkmcnt(12)
    v_mfma_f32_32x32x16_bf16 v[120:135], v[52:55], v[212:215], v[120:135]
    s_waitcnt lgkmcnt(10)
    v_mfma_f32_32x32x16_bf16 v[120:135], v[56:59], v[216:219], v[120:135]
    s_waitcnt lgkmcnt(8)
    v_mfma_f32_32x32x16_bf16 v[120:135], v[60:63], v[220:223], v[120:135]
    s_waitcnt lgkmcnt(6)
    v_mfma_f32_32x32x16_bf16 v[120:135], v[64:67], v[224:227], v[120:135]
    s_waitcnt lgkmcnt(4)
    v_mfma_f32_32x32x16_bf16 v[120:135], v[68:71], v[228:231], v[120:135]
    s_waitcnt lgkmcnt(2)
    v_mfma_f32_32x32x16_bf16 v[120:135], v[72:75], v[232:235], v[120:135]
    s_waitcnt lgkmcnt(0)
    v_mfma_f32_32x32x16_bf16 v[120:135], v[76:79], v[236:239], v[120:135]
    s_waitcnt vmcnt(4)
    s_mov_b64 exec, s[60:61]
    ds_write_b64 v160, v[80:81] offset:21696
    s_mov_b64 exec, s[62:63]
    ds_write_b64 v161, v[82:83] offset:21696
    s_mov_b64 exec, s[64:65]
    ds_write_b64 v162, v[84:85] offset:21696
    s_mov_b64 exec, s[66:67]
    ds_write_b64 v163, v[86:87] offset:21696
    s_mov_b64 exec, s[68:69]
    ds_write_b64 v164, v[88:89] offset:21696
    s_mov_b64 exec, s[70:71]
    ds_write_b64 v165, v[90:91] offset:21696
    s_mov_b64 exec, -1
    s_waitcnt lgkmcnt(0)
    s_barrier
L_nou:
    s_waitcnt lgkmcnt(0)
    v_mov_b32 v20, v40
    v_mov_b32 v22, v41
    s_add_u32 m0, s54, 0x8000
    s_nop 0
    buffer_load_dwordx4 v[20:21], s[28:31], 0 idxen offen lds
    s_add_u32 m0, s54, 0x8400
    s_nop 0
    buffer_load_dwordx4 v[22:23], s[28:31], 0 idxen offen lds
    v_mov_b32 v20, v42
    v_mov_b32 v22, v43
    s_add_u32 m0, s54, 0xc000
    s_nop 0
    buffer_load_dwordx4 v[20:21], s[28:31], 0 idxen offen lds
    s_add_u32 m0, s54, 0xc400
    s_nop 0
    buffer_load_dwordx4 v[22:23], s[28:31], 0 idxen offen lds
    v_mov_b32 v34, 0
    s_cmp_eq_u32 s49, 0
    s_cbranch_scc1 L_flush_done
    ds_read_b128 v[160:163], v9 offset:0
    ds_read_b128 v[164:167], v9 offset:14464
    ds_read_b32 v20, v11 offset:512
    ds_read_b32 v22, v11 offset:576
    v_mov_b32 v96, 0
    v_mov_b32 v168, 0
    v_mov_b32 v97, 0
    v_mov_b32 v169, 0
    v_mov_b32 v98, 0
    v_mov_b32 v170, 0
    v_mov_b32 v99, 0
    v_mov_b32 v171, 0
    v_mov_b32 v100, 0
    v_mov_b32 v172, 0
    v_mov_b32 v101, 0
    v_mov_b32 v173, 0
    v_mov_b32 v102, 0
    v_mov_b32 v174, 0
    v_mov_b32 v103, 0
    v_mov_b32 v175, 0
    s_waitcnt lgkmcnt(2)
    v_mfma_f32_32x32x16_bf16 v[48:63], v[160:163], v[136:139], 0
    v_mfma_f32_32x32x16_bf16 v[48:63], v[164:167], v[140:143], v[48:63]
    ds_read_b128 v[160:163], v9 offset:512
    ds_read_b128 v[164:167], v9 offset:14976
    s_waitcnt vmcnt(6)
    ds_read_b128 v[152:155], v7 offset:0
    ds_read_b128 v[156:159], v8 offset:0
    s_waitcnt lgkmcnt(0)
    v_mfma_f32_32x32x16_bf16 v[48:63], v[152:155], v[144:147], v[48:63]
    v_mfma_f32_32x32x16_bf16 v[48:63], v[156:159], v[148:151], v[48:63]
    s_mov_b32 m0, s54
    s_nop 0
    buffer_load_dwordx4 v[20:21], s[28:31], 0 idxen offen lds
    s_add_u32 m0, s54, 0x400
    s_nop 0
    buffer_load_dwordx4 v[22:23], s[28:31], 0 idxen offen lds
    ds_read_b32 v20, v11 offset:640
    ds_read_b32 v22, v11 offset:704
    s_waitcnt vmcnt(6)
    ds_read_b128 v[152:155], v7 offset:16384
    ds_read_b128 v[156:159], v8 offset:16384
    s_mov_b32 s50, 0
    s_sub_u32 s52, s49, 6
    s_setprio 3
    s_lshl_b32 s56, s44, 2
    v_mov_b32 v32, s56
    v_mov_b32 v33, -1
    s_nop 3
L_loop:
    s_waitcnt lgkmcnt(0)
    v_mfma_f32_32x32x16_bf16 v[64:79], v[152:155], v[144:147], 0
    s_add_u32 m0, s54, 0x4000
    v_exp_f32 v80, v48
    v_exp_f32 v81, v49
    buffer_load_dwordx4 v[20:21], s[28:31], 0 idxen offen lds
    s_add_u32 m0, s54, 0x4400
    v_exp_f32 v82, v50
    v_exp_f32 v83, v51
    v_mfma_f32_32x32x16_bf16 v[64:79], v[156:159], v[148:151], v[64:79]
    buffer_load_dwordx4 v[22:23], s[28:31], 0 idxen offen lds
    v_exp_f32 v84, v52
    v_exp_f32 v85, v53
    v_exp_f32 v86, v54
    v_exp_f32 v87, v55
    v_mfma_f32_32x32x16_bf16 v[64:79], v[160:163], v[136:139], v[64:79]
    v_exp_f32 v88, v56
    v_exp_f32 v89, v57
    v_exp_f32 v90, v58
    v_exp_f32 v91, v59
    v_exp_f32 v92, v60
    v_exp_f32 v93, v61
    v_exp_f32 v94, v62
    v_exp_f32 v95, v63
    v_pk_add_f32 v[80:81], v[80:81], 1.0 op_sel_hi:[1,0]
    v_pk_add_f32 v[82:83], v[82:83], 1.0 op_sel_hi:[1,0]
    v_pk_add_f32 v[84:85], v[84:85], 1.0 op_sel_hi:[1,0]
    v_pk_add_f32 v[86:87], v[86:87], 1.0 op_sel_hi:[1,0]
    v_pk_add_f32 v[88:89], v[88:89], 1.0 op_sel_hi:[1,0]
    v_pk_add_f32 v[90:91], v[90:91], 1.0 op_sel_hi:[1,0]
    v_pk_add_f32 v[92:93], v[92:93], 1.0 op_sel_hi:[1,0]
    v_pk_add_f32 v[94:95], v[94:95], 1.0 op_sel_hi:[1,0]
    v_mfma_f32_32x32x16_bf16 v[64:79], v[164:167], v[140:143], v[64:79]
    v_rcp_f32 v80, v80
    v_rcp_f32 v81, v81
    v_rcp_f32 v82, v82
    v_rcp_f32 v83, v83
    v_mfma_f32_32x32x16_bf16 v[104:119], v[96:99], v[168:171], v[104:119]
    v_rcp_f32 v84, v84
    v_rcp_f32 v85, v85
    v_rcp_f32 v86, v86
    v_rcp_f32 v87, v87
    v_mfma_f32_32x32x16_bf16 v[104:119], v[100:103], v[172:175], v[104:119]
    ds_read_b32 v20, v11 offset:768
    ds_read_b32 v22, v11 offset:832
    v_rcp_f32 v88, v88
    v_rcp_f32 v89, v89
    ds_read_b128 v[160:163], v9 offset:1024
    ds_read_b128 v[164:167], v9 offset:15488
    v_rcp_f32 v90, v90
    v_rcp_f32 v91, v91
    ds_read_b64_tr_b16 v[168:169], v10 offset:0
    ds_read_b64_tr_b16 v[170:171], v10 offset:128
    ds_read_b64_tr_b16 v[172:173], v10 offset:256
    ds_read_b64_tr_b16 v[174:175], v10 offset:384
    v_rcp_f32 v92, v92
    v_rcp_f32 v93, v93
    s_waitcnt vmcnt(6)
    ds_read_b128 v[152:155], v7 offset:32768
    ds_read_b128 v[156:159], v8 offset:32768
    s_add_u32 s50, s50, 1
    v_rcp_f32 v94, v94
    v_rcp_f32 v95, v95
    s_cmp_eq_u32 s50, s52
    s_cbranch_scc1 L_pr0
L_prr0:
    v_pk_mul_f32 v[80:81], v[80:81], v[48:49]
    v_pk_mul_f32 v[82:83], v[82:83], v[50:51]
    v_pk_mul_f32 v[84:85], v[84:85], v[52:53]
    v_pk_mul_f32 v[86:87], v[86:87], v[54:55]
    v_pk_mul_f32 v[88:89], v[88:89], v[56:57]
    v_pk_mul_f32 v[90:91], v[90:91], v[58:59]
    v_pk_mul_f32 v[92:93], v[92:93], v[60:61]
    v_pk_mul_f32 v[94:95], v[94:95], v[62:63]
    s_cmp_ge_u32 s50, s49
    v_cvt_pk_bf16_f32 v96, v80, v81
    v_cvt_pk_bf16_f32 v97, v82, v83
    v_cvt_pk_bf16_f32 v98, v84, v85
    v_cvt_pk_bf16_f32 v99, v86, v87
    v_cvt_pk_bf16_f32 v100, v88, v89
    v_cvt_pk_bf16_f32 v101, v90, v91
    v_cvt_pk_bf16_f32 v102, v92, v93
    v_cvt_pk_bf16_f32 v103, v94, v95
    s_cbranch_scc1 L_loop_end
    s_waitcnt lgkmcnt(0)
    v_mfma_f32_32x32x16_bf16 v[48:63], v[152:155], v[144:147], 0
    s_add_u32 m0, s54, 0x8000
    v_exp_f32 v80, v64
    v_exp_f32 v81, v65
    buffer_load_dwordx4 v[20:21], s[28:31], 0 idxen offen lds
    s_add_u32 m0, s54, 0x8400
    v_exp_f32 v82, v66
    v_exp_f32 v83, v67
    v_mfma_f32_32x32x16_bf16 v[48:63], v[156:159], v[148:151], v[48:63]
    buffer_load_dwordx4 v[22:23], s[28:31], 0 idxen offen lds
    v_exp_f32 v84, v68
    v_exp_f32 v85, v69
    v_exp_f32 v86, v70
    v_exp_f32 v87, v71
    v_mfma_f32_32x32x16_bf16 v[48:63], v[160:163], v[136:139], v[48:63]
    v_exp_f32 v88, v72
    v_exp_f32 v89, v73
    v_exp_f32 v90, v74
    v_exp_f32 v91, v75
    v_exp_f32 v92, v76
    v_exp_f32 v93, v77
    v_exp_f32 v94, v78
    v_exp_f32 v95, v79
    v_pk_add_f32 v[80:81], v[80:81], 1.0 op_sel_hi:[1,0]
    v_pk_add_f32 v[82:83], v[82:83], 1.0 op_sel_hi:[1,0]
    v_pk_add_f32 v[84:85], v[84:85], 1.0 op_sel_hi:[1,0]
    v_pk_add_f32 v[86:87], v[86:87], 1.0 op_sel_hi:[1,0]
    v_pk_add_f32 v[88:89], v[88:89], 1.0 op_sel_hi:[1,0]
    v_pk_add_f32 v[90:91], v[90:91], 1.0 op_sel_hi:[1,0]
    v_pk_add_f32 v[92:93], v[92:93], 1.0 op_sel_hi:[1,0]
    v_pk_add_f32 v[94:95], v[94:95], 1.0 op_sel_hi:[1,0]
    v_mfma_f32_32x32x16_bf16 v[48:63], v[164:167], v[140:143], v[48:63]
    v_rcp_f32 v80, v80
    v_rcp_f32 v81, v81
    v_rcp_f32 v82, v82
    v_rcp_f32 v83, v83
    v_mfma_f32_32x32x16_bf16 v[104:119], v[96:99], v[168:171], v[104:119]
    v_rcp_f32 v84, v84
    v_rcp_f32 v85, v85
    v_rcp_f32 v86, v86
    v_rcp_f32 v87, v87
    v_mfma_f32_32x32x16_bf16 v[104:119], v[100:103], v[172:175], v[104:119]
    ds_read_b32 v20, v11 offset:896
    ds_read_b32 v22, v11 offset:960
    v_rcp_f32 v88, v88
    v_rcp_f32 v89, v89
    ds_read_b128 v[160:163], v9 offset:1536
    ds_read_b128 v[164:167], v9 offset:16000
    v_rcp_f32 v90, v90
    v_rcp_f32 v91, v91
    ds_read_b64_tr_b16 v[168:169], v10 offset:512
    ds_read_b64_tr_b16 v[170:171], v10 offset:640
    ds_read_b64_tr_b16 v[172:173], v10 offset:768
    ds_read_b64_tr_b16 v[174:175], v10 offset:896
    v_rcp_f32 v92, v92
    v_rcp_f32 v93, v93
    s_waitcnt vmcnt(6)
    ds_read_b128 v[152:155], v7 offset:49152
    ds_read_b128 v[156:159], v8 offset:49152
    s_add_u32 s50, s50, 1
    v_rcp_f32 v94, v94
    v_rcp_f32 v95, v95
    s_cmp_eq_u32 s50, s52
    s_cbranch_scc1 L_pr1
L_prr1:
    v_pk_mul_f32 v[80:81], v[80:81], v[64:65]
    v_pk_mul_f32 v[82:83], v[82:83], v[66:67]
    v_pk_mul_f32 v[84:85], v[84:85], v[68:69]
    v_pk_mul_f32 v[86:87], v[86:87], v[70:71]
    v_pk_mul_f32 v[88:89], v[88:89], v[72:73]
    v_pk_mul_f32 v[90:91], v[90:91], v[74:75]
    v_pk_mul_f32 v[92:93], v[92:93], v[76:77]
    v_pk_mul_f32 v[94:95], v[94:95], v[78:79]
    s_cmp_ge_u32 s50, s49
    v_cvt_pk_bf16_f32 v96, v80, v81
    v_cvt_pk_bf16_f32 v97, v82, v83
    v_cvt_pk_bf16_f32 v98, v84, v85
    v_cvt_pk_bf16_f32 v99, v86, v87
    v_cvt_pk_bf16_f32 v100, v88, v89
    v_cvt_pk_bf16_f32 v101, v90, v91
    v_cvt_pk_bf16_f32 v102, v92, v93
    v_cvt_pk_bf16_f32 v103, v94, v95
    s_cbranch_scc1 L_loop_end
    s_waitcnt lgkmcnt(0)
    v_mfma_f32_32x32x16_bf16 v[64:79], v[152:155], v[144:147], 0
    s_add_u32 m0, s54, 0xc000
    v_exp_f32 v80, v48
    v_exp_f32 v81, v49
    buffer_load_dwordx4 v[20:21], s[28:31], 0 idxen offen lds
    s_add_u32 m0, s54, 0xc400
    v_exp_f32 v82, v50
    v_exp_f32 v83, v51
    v_mfma_f32_32x32x16_bf16 v[64:79], v[156:159], v[148:151], v[64:79]
    buffer_load_dwordx4 v[22:23], s[28:31], 0 idxen offen lds
    v_exp_f32 v84, v52
    v_exp_f32 v85, v53
    v_exp_f32 v86, v54
    v_exp_f32 v87, v55
    v_mfma_f32_32x32x16_bf16 v[64:79], v[160:163], v[136:139], v[64:79]
    v_exp_f32 v88, v56
    v_exp_f32 v89, v57
    v_exp_f32 v90, v58
    v_exp_f32 v91, v59
    v_exp_f32 v92, v60
    v_exp_f32 v93, v61
    v_exp_f32 v94, v62
    v_exp_f32 v95, v63
    v_pk_add_f32 v[80:81], v[80:81], 1.0 op_sel_hi:[1,0]
    v_pk_add_f32 v[82:83], v[82:83], 1.0 op_sel_hi:[1,0]
    v_pk_add_f32 v[84:85], v[84:85], 1.0 op_sel_hi:[1,0]
    v_pk_add_f32 v[86:87], v[86:87], 1.0 op_sel_hi:[1,0]
    v_pk_add_f32 v[88:89], v[88:89], 1.0 op_sel_hi:[1,0]
    v_pk_add_f32 v[90:91], v[90:91], 1.0 op_sel_hi:[1,0]
    v_pk_add_f32 v[92:93], v[92:93], 1.0 op_sel_hi:[1,0]
    v_pk_add_f32 v[94:95], v[94:95], 1.0 op_sel_hi:[1,0]
    v_mfma_f32_32x32x16_bf16 v[64:79], v[164:167], v[140:143], v[64:79]
    v_rcp_f32 v80, v80
    v_rcp_f32 v81, v81
    v_rcp_f32 v82, v82
    v_rcp_f32 v83, v83
    v_mfma_f32_32x32x16_bf16 v[104:119], v[96:99], v[168:171], v[104:119]
    v_rcp_f32 v84, v84
    v_rcp_f32 v85, v85
    v_rcp_f32 v86, v86
    v_rcp_f32 v87, v87
    v_mfma_f32_32x32x16_bf16 v[104:119], v[100:103], v[172:175], v[104:119]
    ds_read_b32 v20, v11 offset:1024
    ds_read_b32 v22, v11 offset:1088
    v_rcp_f32 v88, v88
    v_rcp_f32 v89, v89
    ds_read_b128 v[160:163], v9 offset:2048
    ds_read_b128 v[164:167], v9 offset:16512
    v_rcp_f32 v90, v90
    v_rcp_f32 v91, v91
    ds_read_b64_tr_b16 v[168:169], v10 offset:1024
    ds_read_b64_tr_b16 v[170:171], v10 offset:1152
    ds_read_b64_tr_b16 v[172:173], v10 offset:1280
    ds_read_b64_tr_b16 v[174:175], v10 offset:1408
    v_rcp_f32 v92, v92
    v_rcp_f32 v93, v93
    s_waitcnt vmcnt(6)
    ds_read_b128 v[152:155], v7 offset:0
    ds_read_b128 v[156:159], v8 offset:0
    s_add_u32 s50, s50, 1
    v_rcp_f32 v94, v94
    v_rcp_f32 v95, v95
    s_cmp_eq_u32 s50, s52
    s_cbranch_scc1 L_pr2
L_prr2:
    v_pk_mul_f32 v[80:81], v[80:81], v[48:49]
    v_pk_mul_f32 v[82:83], v[82:83], v[50:51]
    v_pk_mul_f32 v[84:85], v[84:85], v[52:53]
    v_pk_mul_f32 v[86:87], v[86:87], v[54:55]
    v_pk_mul_f32 v[88:89], v[88:89], v[56:57]
    v_pk_mul_f32 v[90:91], v[90:91], v[58:59]
    v_pk_mul_f32 v[92:93], v[92:93], v[60:61]
    v_pk_mul_f32 v[94:95], v[94:95], v[62:63]
    s_cmp_ge_u32 s50, s49
    v_cvt_pk_bf16_f32 v96, v80, v81
    v_cvt_pk_bf16_f32 v97, v82, v83
    v_cvt_pk_bf16_f32 v98, v84, v85
    v_cvt_pk_bf16_f32 v99, v86, v87
    v_cvt_pk_bf16_f32 v100, v88, v89
    v_cvt_pk_bf16_f32 v101, v90, v91
    v_cvt_pk_bf16_f32 v102, v92, v93
    v_cvt_pk_bf16_f32 v103, v94, v95
    s_cbranch_scc1 L_loop_end
    s_waitcnt lgkmcnt(0)
    v_mfma_f32_32x32x16_bf16 v[48:63], v[152:155], v[144:147], 0
    s_mov_b32 m0, s54
    v_exp_f32 v80, v64
    v_exp_f32 v81, v65
    buffer_load_dwordx4 v[20:21], s[28:31], 0 idxen offen lds
    s_add_u32 m0, s54, 0x400
    v_exp_f32 v82, v66
    v_exp_f32 v83, v67
    v_mfma_f32_32x32x16_bf16 v[48:63], v[156:159], v[148:151], v[48:63]
    buffer_load_dwordx4 v[22:23], s[28:31], 0 idxen offen lds
    v_exp_f32 v84, v68
    v_exp_f32 v85, v69
    v_exp_f32 v86, v70
    v_exp_f32 v87, v71
    v_mfma_f32_32x32x16_bf16 v[48:63], v[160:163], v[136:139], v[48:63]
    v_exp_f32 v88, v72
    v_exp_f32 v89, v73
    v_exp_f32 v90, v74
    v_exp_f32 v91, v75
    v_exp_f32 v92, v76
    v_exp_f32 v93, v77
    v_exp_f32 v94, v78
    v_exp_f32 v95, v79
    v_pk_add_f32 v[80:81], v[80:81], 1.0 op_sel_hi:[1,0]
    v_pk_add_f32 v[82:83], v[82:83], 1.0 op_sel_hi:[1,0]
    v_pk_add_f32 v[84:85], v[84:85], 1.0 op_sel_hi:[1,0]
    v_pk_add_f32 v[86:87], v[86:87], 1.0 op_sel_hi:[1,0]
    v_pk_add_f32 v[88:89], v[88:89], 1.0 op_sel_hi:[1,0]
    v_pk_add_f32 v[90:91], v[90:91], 1.0 op_sel_hi:[1,0]
    v_pk_add_f32 v[92:93], v[92:93], 1.0 op_sel_hi:[1,0]
    v_pk_add_f32 v[94:95], v[94:95], 1.0 op_sel_hi:[1,0]
    v_mfma_f32_32x32x16_bf16 v[48:63], v[164:167], v[140:143], v[48:63]
    v_rcp_f32 v80, v80
    v_rcp_f32 v81, v81
    v_rcp_f32 v82, v82
    v_rcp_f32 v83, v83
    v_mfma_f32_32x32x16_bf16 v[104:119], v[96:99], v[168:171], v[104:119]
    v_rcp_f32 v84, v84
    v_rcp_f32 v85, v85
    v_rcp_f32 v86, v86
    v_rcp_f32 v87, v87
    v_mfma_f32_32x32x16_bf16 v[104:119], v[100:103], v[172:175], v[104:119]
    ds_read_b32 v20, v11 offset:1152
    ds_read_b32 v22, v11 offset:1216
    v_rcp_f32 v88, v88
    v_rcp_f32 v89, v89
    ds_read_b128 v[160:163], v9 offset:2560
    ds_read_b128 v[164:167], v9 offset:17024
    v_rcp_f32 v90, v90
    v_rcp_f32 v91, v91
    ds_read_b64_tr_b16 v[168:169], v10 offset:1536
    ds_read_b64_tr_b16 v[170:171], v10 offset:1664
    ds_read_b64_tr_b16 v[172:173], v10 offset:1792
    ds_read_b64_tr_b16 v[174:175], v10 offset:1920
    v_rcp_f32 v92, v92
    v_rcp_f32 v93, v93
    s_waitcnt vmcnt(6)
    ds_read_b128 v[152:155], v7 offset:16384
    ds_read_b128 v[156:159], v8 offset:16384
    s_add_u32 s50, s50, 1
    v_rcp_f32 v94, v94
    v_rcp_f32 v95, v95
    s_cmp_eq_u32 s50, s52
    s_cbranch_scc1 L_pr3
L_prr3:
    v_pk_mul_f32 v[80:81], v[80:81], v[64:65]
    v_pk_mul_f32 v[82:83], v[82:83], v[66:67]
    v_pk_mul_f32 v[84:85], v[84:85], v[68:69]
    v_pk_mul_f32 v[86:87], v[86:87], v[70:71]
    v_pk_mul_f32 v[88:89], v[88:89], v[72:73]
    v_pk_mul_f32 v[90:91], v[90:91], v[74:75]
    v_pk_mul_f32 v[92:93], v[92:93], v[76:77]
    v_pk_mul_f32 v[94:95], v[94:95], v[78:79]
    s_cmp_ge_u32 s50, s49
    v_cvt_pk_bf16_f32 v96, v80, v81
    v_cvt_pk_bf16_f32 v97, v82, v83
    v_cvt_pk_bf16_f32 v98, v84, v85
    v_cvt_pk_bf16_f32 v99, v86, v87
    v_cvt_pk_bf16_f32 v100, v88, v89
    v_cvt_pk_bf16_f32 v101, v90, v91
    v_cvt_pk_bf16_f32 v102, v92, v93
    v_cvt_pk_bf16_f32 v103, v94, v95
    v_add_u32 v9, 2048, v9
    v_add_u32 v10, 2048, v10
    v_add_u32 v11, 512, v11
    s_cbranch_scc0 L_loop
L_loop_end:
    s_waitcnt lgkmcnt(0)
    s_nop 0
    v_mfma_f32_32x32x16_bf16 v[104:119], v[96:99], v[168:171], v[104:119]
    v_mfma_f32_32x32x16_bf16 v[104:119], v[100:103], v[172:175], v[104:119]
L_flush_done:
    s_cmp_lg_u32 s51, 0
    s_cbranch_scc1 L_slow_ret
L_epi:
    s_cmp_eq_u32 s55, 0
    s_cbranch_scc1 L_wiss
L_wissd:
    v_and_b32 v24, 0x13, v1
    v_bfe_u32 v25, v1, 2, 1
    v_lshl_or_b32 v24, v25, 3, v24
    v_bfe_u32 v25, v1, 3, 1
    v_lshl_or_b32 v24, v25, 2, v24
    v_bfe_u32 v25, v24, 2, 2
    v_lshlrev_b32 v25, 4, v25
    v_lshl_add_u32 v24, v24, 6, v25
    v_lshrrev_b32 v25, 5, v1
    v_lshl_add_u32 v24, v25, 3, v24
    v_add_u32 v24, s54, v24
    v_xor_b32 v25, 16, v24
    v_xor_b32 v26, 32, v24
    v_xor_b32 v27, 48, v24
    v_pk_mul_f32 v[104:105], v[104:105], s[96:97]
    v_pk_mul_f32 v[106:107], v[106:107], s[96:97]
    v_pk_mul_f32 v[108:109], v[108:109], s[96:97]
    v_pk_mul_f32 v[110:111], v[110:111], s[96:97]
    v_pk_mul_f32 v[112:113], v[112:113], s[96:97]
    v_pk_mul_f32 v[114:115], v[114:115], s[96:97]
    v_pk_mul_f32 v[116:117], v[116:117], s[96:97]
    v_pk_mul_f32 v[118:119], v[118:119], s[96:97]
    v_cvt_pk_bf16_f32 v96, v104, v105
    v_cvt_pk_bf16_f32 v97, v106, v107
    v_cvt_pk_bf16_f32 v98, v108, v109
    v_cvt_pk_bf16_f32 v99, v110, v111
    v_cvt_pk_bf16_f32 v100, v112, v113
    v_cvt_pk_bf16_f32 v101, v114, v115
    v_cvt_pk_bf16_f32 v102, v116, v117
    v_cvt_pk_bf16_f32 v103, v118, v119
    s_waitcnt vmcnt(0)
    ds_write_b64 v24, v[96:97]
    ds_write_b64 v25, v[98:99]
    ds_write_b64 v26, v[100:101]
    ds_write_b64 v27, v[102:103]
    s_lshl_b32 s56, s45, 13
    s_add_u32 s56, s56, 0x10000
    v_add_u32 v45, s56, v3
    v_add_u32 v46, s56, v4
    v_add_u32 v44, 0x20000, v6
    s_waitcnt lgkmcnt(0)
    v_cmp_eq_u32 vcc, -1, v34
    s_barrier
    s_cbranch_vccz L_wlate
L_wok:
    ds_read_b128 v[208:211], v45 offset:0
    ds_read_b128 v[212:215], v46 offset:0
    ds_read_b128 v[216:219], v45 offset:2048
    ds_read_b128 v[220:223], v46 offset:2048
    ds_read_b128 v[224:227], v45 offset:4096
    ds_read_b128 v[228:231], v46 offset:4096
    ds_read_b128 v[232:235], v45 offset:6144
    ds_read_b128 v[236:239], v46 offset:6144
    s_waitcnt lgkmcnt(7)
    v_mfma_f32_32x32x16_bf16 v[120:135], v[176:179], v[208:211], v[120:135]
    s_waitcnt lgkmcnt(6)
    v_mfma_f32_32x32x16_bf16 v[120:135], v[180:183], v[212:215], v[120:135]
    s_waitcnt lgkmcnt(5)
    v_mfma_f32_32x32x16_bf16 v[120:135], v[184:187], v[216:219], v[120:135]
    s_waitcnt lgkmcnt(4)
    v_mfma_f32_32x32x16_bf16 v[120:135], v[188:191], v[220:223], v[120:135]
    s_waitcnt lgkmcnt(3)
    v_mfma_f32_32x32x16_bf16 v[120:135], v[192:195], v[224:227], v[120:135]
    s_waitcnt lgkmcnt(2)
    v_mfma_f32_32x32x16_bf16 v[120:135], v[196:199], v[228:231], v[120:135]
    s_waitcnt lgkmcnt(1)
    v_mfma_f32_32x32x16_bf16 v[120:135], v[200:203], v[232:235], v[120:135]
    s_waitcnt lgkmcnt(0)
    v_mfma_f32_32x32x16_bf16 v[120:135], v[204:207], v[236:239], v[120:135]
    v_lshrrev_b32 v24, 2, v1
    s_lshl_b32 s56, s45, 8
    s_add_u32 s56, s56, s2
    v_lshl_add_u32 v20, v24, 9, s56
    v_add_u32 v22, 0x2000, v20
    s_add_u32 s56, s54, 0x4000
    v_add_u32 v26, s56, v12
    v_xor_b32 v27, 16, v26
    v_lshl_add_u32 v40, v1, 4, s56
    s_mov_b32 s24, s16
    s_or_b32 s25, s17, 0x1000000
    s_mov_b32 s26, 10000
    s_mov_b32 s27, 0x20000
    v_pk_mul_f32 v[80:81], v[120:121], s[94:95]
    v_pk_mul_f32 v[82:83], v[122:123], s[94:95]
    v_pk_mul_f32 v[84:85], v[124:125], s[94:95]
    v_pk_mul_f32 v[86:87], v[126:127], s[94:95]
    v_pk_mul_f32 v[88:89], v[128:129], s[94:95]
    v_pk_mul_f32 v[90:91], v[130:131], s[94:95]
    v_pk_mul_f32 v[92:93], v[132:133], s[94:95]
    v_pk_mul_f32 v[94:95], v[134:135], s[94:95]
    v_exp_f32 v80, v80
    v_exp_f32 v81, v81
    v_exp_f32 v82, v82
    v_exp_f32 v83, v83
    v_exp_f32 v84, v84
    v_exp_f32 v85, v85
    v_exp_f32 v86, v86
    v_exp_f32 v87, v87
    v_exp_f32 v88, v88
    v_exp_f32 v89, v89
    v_exp_f32 v90, v90
    v_exp_f32 v91, v91
    v_exp_f32 v92, v92
    v_exp_f32 v93, v93
    v_exp_f32 v94, v94
    v_exp_f32 v95, v95
    v_pk_add_f32 v[80:81], v[80:81], 1.0 op_sel_hi:[1,0]
    v_pk_add_f32 v[82:83], v[82:83], 1.0 op_sel_hi:[1,0]
    v_pk_add_f32 v[84:85], v[84:85], 1.0 op_sel_hi:[1,0]
    v_pk_add_f32 v[86:87], v[86:87], 1.0 op_sel_hi:[1,0]
    v_pk_add_f32 v[88:89], v[88:89], 1.0 op_sel_hi:[1,0]
    v_pk_add_f32 v[90:91], v[90:91], 1.0 op_sel_hi:[1,0]
    v_pk_add_f32 v[92:93], v[92:93], 1.0 op_sel_hi:[1,0]
    v_pk_add_f32 v[94:95], v[94:95], 1.0 op_sel_hi:[1,0]
    v_rcp_f32 v80, v80
    v_rcp_f32 v81, v81
    v_rcp_f32 v82, v82
    v_rcp_f32 v83, v83
    v_rcp_f32 v84, v84
    v_rcp_f32 v85, v85
    v_rcp_f32 v86, v86
    v_rcp_f32 v87, v87
    v_rcp_f32 v88, v88
    v_rcp_f32 v89, v89
    v_rcp_f32 v90, v90
    v_rcp_f32 v91, v91
    v_rcp_f32 v92, v92
    v_rcp_f32 v93, v93
    v_rcp_f32 v94, v94
    v_rcp_f32 v95, v95
    v_pk_mul_f32 v[80:81], v[80:81], v[120:121]
    v_pk_mul_f32 v[82:83], v[82:83], v[122:123]
    v_pk_mul_f32 v[84:85], v[84:85], v[124:125]
    v_pk_mul_f32 v[86:87], v[86:87], v[126:127]
    v_pk_mul_f32 v[88:89], v[88:89], v[128:129]
    v_pk_mul_f32 v[90:91], v[90:91], v[130:131]
    v_pk_mul_f32 v[92:93], v[92:93], v[132:133]
    v_pk_mul_f32 v[94:95], v[94:95], v[134:135]
    v_cvt_pk_bf16_f32 v96, v80, v81
    v_cvt_pk_bf16_f32 v97, v82, v83
    v_cvt_pk_bf16_f32 v98, v84, v85
    v_cvt_pk_bf16_f32 v99, v86, v87
    v_cvt_pk_bf16_f32 v100, v88, v89
    v_cvt_pk_bf16_f32 v101, v90, v91
    v_cvt_pk_bf16_f32 v102, v92, v93
    v_cvt_pk_bf16_f32 v103, v94, v95
    ds_write_b128 v26, v[96:99]
    ds_write_b128 v27, v[100:103]
    ds_read_b128 v[96:99], v40
    ds_read_b128 v[100:103], v40 offset:1024
    s_waitcnt lgkmcnt(1)
    buffer_store_dwordx4 v[96:99], v[20:21], s[24:27], 0 idxen offen
    s_waitcnt lgkmcnt(0)
    buffer_store_dwordx4 v[100:103], v[22:23], s[24:27], 0 idxen offen
L_end:
    s_endpgm
L_pr0:
    s_sub_u32 s56, s49, s50
    s_cmp_eq_u32 s56, 6
    s_cbranch_scc0 L_prb0
    s_setprio 2
    s_add_u32 m0, s57, 0x20000
    v_add_u32 v44, 0x8000, v13
    global_load_lds_dwordx4 v44, s[14:15]
    s_add_u32 m0, s57, 0x20400
    v_add_u32 v44, 0x9000, v13
    global_load_lds_dwordx4 v44, s[14:15]
    s_add_u32 m0, s57, 0x20800
    v_add_u32 v44, 0xa000, v13
    global_load_lds_dwordx4 v44, s[14:15]
    s_add_u32 m0, s57, 0x20c00
    v_add_u32 v44, 0xb000, v13
    global_load_lds_dwordx4 v44, s[14:15]
    s_mov_b32 s55, 1
    s_or_b32 s56, s2, s44
    s_cbranch_scc1 L_noeps0
    v_mov_b32 v25, 0
    v_mov_b32 v26, s48
    s_mov_b64 exec, 1
    global_store_dword v25, v26, s[20:21] sc1
    s_mov_b64 exec, -1
L_noeps0:
    s_sub_u32 s52, s49, 3
    s_branch L_prr0
L_prb0:
    s_cmp_eq_u32 s56, 3
    s_cbranch_scc0 L_prc0
    s_setprio 1
    ds_write_b32 v32, v33 offset:62976
    s_sub_u32 s52, s49, 1
    s_branch L_prr0
L_prc0:
    s_setprio 0
    v_xor_b32 v32, 16, v32
    ds_read_b32 v34, v32 offset:62976
    v_add_u32 v44, 0x20000, v6
    ds_read_b64_tr_b16 v[176:177], v44 offset:0
    ds_read_b64_tr_b16 v[178:179], v44 offset:256
    ds_read_b64_tr_b16 v[180:181], v44 offset:1024
    ds_read_b64_tr_b16 v[182:183], v44 offset:1280
    ds_read_b64_tr_b16 v[184:185], v44 offset:2048
    ds_read_b64_tr_b16 v[186:187], v44 offset:2304
    ds_read_b64_tr_b16 v[188:189], v44 offset:3072
    ds_read_b64_tr_b16 v[190:191], v44 offset:3328
    ds_read_b64_tr_b16 v[192:193], v44 offset:4096
    ds_read_b64_tr_b16 v[194:195], v44 offset:4352
    ds_read_b64_tr_b16 v[196:197], v44 offset:5120
    ds_read_b64_tr_b16 v[198:199], v44 offset:5376
    ds_read_b64_tr_b16 v[200:201], v44 offset:6144
    ds_read_b64_tr_b16 v[202:203], v44 offset:6400
    ds_read_b64_tr_b16 v[204:205], v44 offset:7168
    ds_read_b64_tr_b16 v[206:207], v44 offset:7424
    s_branch L_prr0
L_pr1:
    s_sub_u32 s56, s49, s50
    s_cmp_eq_u32 s56, 6
    s_cbranch_scc0 L_prb1
    s_setprio 2
    s_add_u32 m0, s57, 0x20000
    v_add_u32 v44, 0x8000, v13
    global_load_lds_dwordx4 v44, s[14:15]
    s_add_u32 m0, s57, 0x20400
    v_add_u32 v44, 0x9000, v13
    global_load_lds_dwordx4 v44, s[14:15]
    s_add_u32 m0, s57, 0x20800
    v_add_u32 v44, 0xa000, v13
    global_load_lds_dwordx4 v44, s[14:15]
    s_add_u32 m0, s57, 0x20c00
    v_add_u32 v44, 0xb000, v13
    global_load_lds_dwordx4 v44, s[14:15]
    s_mov_b32 s55, 1
    s_or_b32 s56, s2, s44
    s_cbranch_scc1 L_noeps1
    v_mov_b32 v25, 0
    v_mov_b32 v26, s48
    s_mov_b64 exec, 1
    global_store_dword v25, v26, s[20:21] sc1
    s_mov_b64 exec, -1
L_noeps1:
    s_sub_u32 s52, s49, 3
    s_branch L_prr1
L_prb1:
    s_cmp_eq_u32 s56, 3
    s_cbranch_scc0 L_prc1
    s_setprio 1
    ds_write_b32 v32, v33 offset:62976
    s_sub_u32 s52, s49, 1
    s_branch L_prr1
L_prc1:
    s_setprio 0
    v_xor_b32 v32, 16, v32
    ds_read_b32 v34, v32 offset:62976
    v_add_u32 v44, 0x20000, v6
    ds_read_b64_tr_b16 v[176:177], v44 offset:0
    ds_read_b64_tr_b16 v[178:179], v44 offset:256
    ds_read_b64_tr_b16 v[180:181], v44 offset:1024
    ds_read_b64_tr_b16 v[182:183], v44 offset:1280
    ds_read_b64_tr_b16 v[184:185], v44 offset:2048
    ds_read_b64_tr_b16 v[186:187], v44 offset:2304
    ds_read_b64_tr_b16 v[188:189], v44 offset:3072
    ds_read_b64_tr_b16 v[190:191], v44 offset:3328
    ds_read_b64_tr_b16 v[192:193], v44 offset:4096
    ds_read_b64_tr_b16 v[194:195], v44 offset:4352
    ds_read_b64_tr_b16 v[196:197], v44 offset:5120
    ds_read_b64_tr_b16 v[198:199], v44 offset:5376
    ds_read_b64_tr_b16 v[200:201], v44 offset:6144
    ds_read_b64_tr_b16 v[202:203], v44 offset:6400
    ds_read_b64_tr_b16 v[204:205], v44 offset:7168
    ds_read_b64_tr_b16 v[206:207], v44 offset:7424
    s_branch L_prr1
L_pr2:
    s_sub_u32 s56, s49, s50
    s_cmp_eq_u32 s56, 6
    s_cbranch_scc0 L_prb2
    s_setprio 2
    s_add_u32 m0, s57, 0x20000
    v_add_u32 v44, 0x8000, v13
    global_load_lds_dwordx4 v44, s[14:15]
    s_add_u32 m0, s57, 0x20400
    v_add_u32 v44, 0x9000, v13
    global_load_lds_dwordx4 v44, s[14:15]
    s_add_u32 m0, s57, 0x20800
    v_add_u32 v44, 0xa000, v13
    global_load_lds_dwordx4 v44, s[14:15]
    s_add_u32 m0, s57, 0x20c00
    v_add_u32 v44, 0xb000, v13
    global_load_lds_dwordx4 v44, s[14:15]
    s_mov_b32 s55, 1
    s_or_b32 s56, s2, s44
    s_cbranch_scc1 L_noeps2
    v_mov_b32 v25, 0
    v_mov_b32 v26, s48
    s_mov_b64 exec, 1
    global_store_dword v25, v26, s[20:21] sc1
    s_mov_b64 exec, -1
L_noeps2:
    s_sub_u32 s52, s49, 3
    s_branch L_prr2
L_prb2:
    s_cmp_eq_u32 s56, 3
    s_cbranch_scc0 L_prc2
    s_setprio 1
    ds_write_b32 v32, v33 offset:62976
    s_sub_u32 s52, s49, 1
    s_branch L_prr2
L_prc2:
    s_setprio 0
    v_xor_b32 v32, 16, v32
    ds_read_b32 v34, v32 offset:62976
    v_add_u32 v44, 0x20000, v6
    ds_read_b64_tr_b16 v[176:177], v44 offset:0
    ds_read_b64_tr_b16 v[178:179], v44 offset:256
    ds_read_b64_tr_b16 v[180:181], v44 offset:1024
    ds_read_b64_tr_b16 v[182:183], v44 offset:1280
    ds_read_b64_tr_b16 v[184:185], v44 offset:2048
    ds_read_b64_tr_b16 v[186:187], v44 offset:2304
    ds_read_b64_tr_b16 v[188:189], v44 offset:3072
    ds_read_b64_tr_b16 v[190:191], v44 offset:3328
    ds_read_b64_tr_b16 v[192:193], v44 offset:4096
    ds_read_b64_tr_b16 v[194:195], v44 offset:4352
    ds_read_b64_tr_b16 v[196:197], v44 offset:5120
    ds_read_b64_tr_b16 v[198:199], v44 offset:5376
    ds_read_b64_tr_b16 v[200:201], v44 offset:6144
    ds_read_b64_tr_b16 v[202:203], v44 offset:6400
    ds_read_b64_tr_b16 v[204:205], v44 offset:7168
    ds_read_b64_tr_b16 v[206:207], v44 offset:7424
    s_branch L_prr2
L_pr3:
    s_sub_u32 s56, s49, s50
    s_cmp_eq_u32 s56, 6
    s_cbranch_scc0 L_prb3
    s_setprio 2
    s_add_u32 m0, s57, 0x20000
    v_add_u32 v44, 0x8000, v13
    global_load_lds_dwordx4 v44, s[14:15]
    s_add_u32 m0, s57, 0x20400
    v_add_u32 v44, 0x9000, v13
    global_load_lds_dwordx4 v44, s[14:15]
    s_add_u32 m0, s57, 0x20800
    v_add_u32 v44, 0xa000, v13
    global_load_lds_dwordx4 v44, s[14:15]
    s_add_u32 m0, s57, 0x20c00
    v_add_u32 v44, 0xb000, v13
    global_load_lds_dwordx4 v44, s[14:15]
    s_mov_b32 s55, 1
    s_or_b32 s56, s2, s44
    s_cbranch_scc1 L_noeps3
    v_mov_b32 v25, 0
    v_mov_b32 v26, s48
    s_mov_b64 exec, 1
    global_store_dword v25, v26, s[20:21] sc1
    s_mov_b64 exec, -1
L_noeps3:
    s_sub_u32 s52, s49, 3
    s_branch L_prr3
L_prb3:
    s_cmp_eq_u32 s56, 3
    s_cbranch_scc0 L_prc3
    s_setprio 1
    ds_write_b32 v32, v33 offset:62976
    s_sub_u32 s52, s49, 1
    s_branch L_prr3
L_prc3:
    s_setprio 0
    v_xor_b32 v32, 16, v32
    ds_read_b32 v34, v32 offset:62976
    v_add_u32 v44, 0x20000, v6
    ds_read_b64_tr_b16 v[176:177], v44 offset:0
    ds_read_b64_tr_b16 v[178:179], v44 offset:256
    ds_read_b64_tr_b16 v[180:181], v44 offset:1024
    ds_read_b64_tr_b16 v[182:183], v44 offset:1280
    ds_read_b64_tr_b16 v[184:185], v44 offset:2048
    ds_read_b64_tr_b16 v[186:187], v44 offset:2304
    ds_read_b64_tr_b16 v[188:189], v44 offset:3072
    ds_read_b64_tr_b16 v[190:191], v44 offset:3328
    ds_read_b64_tr_b16 v[192:193], v44 offset:4096
    ds_read_b64_tr_b16 v[194:195], v44 offset:4352
    ds_read_b64_tr_b16 v[196:197], v44 offset:5120
    ds_read_b64_tr_b16 v[198:199], v44 offset:5376
    ds_read_b64_tr_b16 v[200:201], v44 offset:6144
    ds_read_b64_tr_b16 v[202:203], v44 offset:6400
    ds_read_b64_tr_b16 v[204:205], v44 offset:7168
    ds_read_b64_tr_b16 v[206:207], v44 offset:7424
    s_branch L_prr3
L_flush:
    s_mul_i32 s56, s45, 2560
    s_add_u32 s56, s56, 57856
    v_and_b32 v11, 60, v1
    v_add_u32 v11, s56, v11
    ds_read2_b32 v[36:37], v11 offset0:0 offset1:16
    ds_read2_b32 v[38:39], v11 offset0:32 offset1:48
    ds_read2_b32 v[40:41], v11 offset0:64 offset1:80
    ds_read2_b32 v[42:43], v11 offset0:96 offset1:112
    s_branch L_flush2
L_wiss:
    s_add_u32 m0, s57, 0x20000
    v_add_u32 v44, 0x8000, v13
    global_load_lds_dwordx4 v44, s[14:15]
    s_add_u32 m0, s57, 0x20400
    v_add_u32 v44, 0x9000, v13
    global_load_lds_dwordx4 v44, s[14:15]
    s_add_u32 m0, s57, 0x20800
    v_add_u32 v44, 0xa000, v13
    global_load_lds_dwordx4 v44, s[14:15]
    s_add_u32 m0, s57, 0x20c00
    v_add_u32 v44, 0xb000, v13
    global_load_lds_dwordx4 v44, s[14:15]
    s_or_b32 s56, s2, s44
    s_cbranch_scc1 L_noepw
    v_mov_b32 v25, 0
    v_mov_b32 v26, s48
    s_mov_b64 exec, 1
    global_store_dword v25, v26, s[20:21] sc1
    s_mov_b64 exec, -1
L_noepw:
    s_branch L_wissd
L_wlate:
    v_add_u32 v44, 0x20000, v6
    ds_read_b64_tr_b16 v[176:177], v44 offset:0
    ds_read_b64_tr_b16 v[178:179], v44 offset:256
    ds_read_b64_tr_b16 v[180:181], v44 offset:1024
    ds_read_b64_tr_b16 v[182:183], v44 offset:1280
    ds_read_b64_tr_b16 v[184:185], v44 offset:2048
    ds_read_b64_tr_b16 v[186:187], v44 offset:2304
    ds_read_b64_tr_b16 v[188:189], v44 offset:3072
    ds_read_b64_tr_b16 v[190:191], v44 offset:3328
    ds_read_b64_tr_b16 v[192:193], v44 offset:4096
    ds_read_b64_tr_b16 v[194:195], v44 offset:4352
    ds_read_b64_tr_b16 v[196:197], v44 offset:5120
    ds_read_b64_tr_b16 v[198:199], v44 offset:5376
    ds_read_b64_tr_b16 v[200:201], v44 offset:6144
    ds_read_b64_tr_b16 v[202:203], v44 offset:6400
    ds_read_b64_tr_b16 v[204:205], v44 offset:7168
    ds_read_b64_tr_b16 v[206:207], v44 offset:7424
    s_waitcnt lgkmcnt(0)
    s_branch L_wok
L_putx32:
    s_and_b64 s[80:81], exec, vcc
    s_mov_b64 exec, s[86:87]
    v_cmp_gt_u32 vcc, 24, v30
    v_subrev_u32 v24, 0x14040, v24
    v_or_b32 v28, 0x80000000, v28
    s_or_b64 exec, vcc, s[80:81]
    s_branch L_putr32
L_putx33:
    s_and_b64 s[80:81], exec, vcc
    s_mov_b64 exec, s[86:87]
    v_cmp_gt_u32 vcc, 24, v31
    v_subrev_u32 v24, 0x14040, v24
    v_or_b32 v29, 0x80000000, v29
    s_or_b64 exec, vcc, s[80:81]
    s_branch L_putr33
L_pub_more:
    s_mov_b64 s[80:81], exec
    s_mov_b64 exec, vcc
    s_mov_b32 s52, 3
    v_or_b32 v30, 2.0, v30
    v_subrev_u32 v36, 0x14000, v43
    ds_read_b128 v[96:99], v36
    ds_read_b128 v[100:103], v36 offset:32
    ds_write_b128 v36, v[120:123]
    ds_write_b128 v36, v[120:123] offset:32
    v_add_u32 v34, 0x402000, v47
    v_add_u32 v35, 0x603000, v47
    v_mov_b32 v36, 0x3fffffff
    s_waitcnt lgkmcnt(0)
    v_cmp_gt_i32 vcc, 0, v96
    v_and_b32 v96, 0x7fffffff, v96
    s_nop 0
    v_cndmask_b32 v96, v36, v96, vcc
    v_cmp_gt_i32 vcc, 0, v97
    v_and_b32 v97, 0x7fffffff, v97
    s_nop 0
    v_cndmask_b32 v97, v36, v97, vcc
    v_cmp_gt_i32 vcc, 0, v98
    v_and_b32 v98, 0x7fffffff, v98
    s_nop 0
    v_cndmask_b32 v98, v36, v98, vcc
    v_cmp_gt_i32 vcc, 0, v100
    v_and_b32 v100, 0x7fffffff, v100
    s_nop 0
    v_cndmask_b32 v100, v36, v100, vcc
    v_cmp_gt_i32 vcc, 0, v101
    v_and_b32 v101, 0x7fffffff, v101
    s_nop 0
    v_cndmask_b32 v101, v36, v101, vcc
    v_cmp_gt_i32 vcc, 0, v102
    v_and_b32 v102, 0x7fffffff, v102
    s_nop 0
    v_cndmask_b32 v102, v36, v102, vcc
    v_cmp_le_u32 vcc, 25, v37
    v_mov_b32 v99, s47
    v_mov_b32 v103, s47
    v_cndmask_b32_e64 v36, 0, 2.0, vcc
    v_or_b32 v102, v36, v102
    global_store_dwordx4 v34, v[96:99], s[20:21] sc1
    global_store_dwordx4 v35, v[100:103], s[20:21] sc1
    s_mov_b64 exec, s[80:81]
    s_branch L_pub_b
L_nextlevel:
    s_cmp_lg_u32 s52, 0
    s_cbranch_scc0 L_nl1
    s_mov_b32 s51, 1
    s_mov_b64 s[90:91], -1
    s_branch L_flags
L_nl1:
    s_waitcnt vmcnt(0)
    s_mov_b64 exec, s[60:61]
    ds_write_b64 v160, v[80:81] offset:21696
    s_mov_b64 exec, s[62:63]
    ds_write_b64 v161, v[82:83] offset:21696
    s_mov_b64 exec, s[64:65]
    ds_write_b64 v162, v[84:85] offset:21696
    s_mov_b64 exec, s[66:67]
    ds_write_b64 v163, v[86:87] offset:21696
    s_mov_b64 exec, s[68:69]
    ds_write_b64 v164, v[88:89] offset:21696
    s_mov_b64 exec, s[70:71]
    ds_write_b64 v165, v[90:91] offset:21696
    s_mov_b64 exec, -1
    s_lshr_b64 s[86:87], s[72:73], 1
    s_or_b64 s[72:73], s[72:73], s[86:87]
    s_mov_b32 s52, 1
    v_add_u32 v2, 0x402000, v2
    s_waitcnt lgkmcnt(0)
    s_branch L_level
L_slow:
    s_waitcnt vmcnt(0)
    v_add_u32 v44, 0x20000, v6
    ds_read_b64_tr_b16 v[48:49], v44 offset:0
    ds_read_b64_tr_b16 v[50:51], v44 offset:256
    ds_read_b64_tr_b16 v[52:53], v44 offset:1024
    ds_read_b64_tr_b16 v[54:55], v44 offset:1280
    ds_read_b64_tr_b16 v[56:57], v44 offset:2048
    ds_read_b64_tr_b16 v[58:59], v44 offset:2304
    ds_read_b64_tr_b16 v[60:61], v44 offset:3072
    ds_read_b64_tr_b16 v[62:63], v44 offset:3328
    ds_read_b64_tr_b16 v[64:65], v44 offset:4096
    ds_read_b64_tr_b16 v[66:67], v44 offset:4352
    ds_read_b64_tr_b16 v[68:69], v44 offset:5120
    ds_read_b64_tr_b16 v[70:71], v44 offset:5376
    ds_read_b64_tr_b16 v[72:73], v44 offset:6144
    ds_read_b64_tr_b16 v[74:75], v44 offset:6400
    ds_read_b64_tr_b16 v[76:77], v44 offset:7168
    ds_read_b64_tr_b16 v[78:79], v44 offset:7424
    s_waitcnt lgkmcnt(14)
    v_mfma_f32_32x32x16_bf16 v[120:135], v[48:51], v[208:211], 0
    s_waitcnt lgkmcnt(12)
    v_mfma_f32_32x32x16_bf16 v[120:135], v[52:55], v[212:215], v[120:135]
    s_waitcnt lgkmcnt(10)
    v_mfma_f32_32x32x16_bf16 v[120:135], v[56:59], v[216:219], v[120:135]
    s_waitcnt lgkmcnt(8)
    v_mfma_f32_32x32x16_bf16 v[120:135], v[60:63], v[220:223], v[120:135]
    s_waitcnt lgkmcnt(6)
    v_mfma_f32_32x32x16_bf16 v[120:135], v[64:67], v[224:227], v[120:135]
    s_waitcnt lgkmcnt(4)
    v_mfma_f32_32x32x16_bf16 v[120:135], v[68:71], v[228:231], v[120:135]
    s_waitcnt lgkmcnt(2)
    v_mfma_f32_32x32x16_bf16 v[120:135], v[72:75], v[232:235], v[120:135]
    s_waitcnt lgkmcnt(0)
    v_mfma_f32_32x32x16_bf16 v[120:135], v[76:79], v[236:239], v[120:135]
    s_nop 7
    s_barrier
    s_mov_b32 s36, s10
    s_mov_b32 s37, s11
    s_mov_b32 s38, 640000
    s_mov_b32 s39, 0x20000
    s_mov_b32 s40, s8
    s_mov_b32 s41, s9
    s_mov_b32 s42, 640000
    s_mov_b32 s43, 0x20000
    s_cmp_lg_u32 s51, 2
    s_cbranch_scc1 L_scan
    v_mov_b32 v24, -1
    v_mov_b32 v25, -1
    v_mov_b32 v26, -1
    v_mov_b32 v27, -1
    v_lshrrev_b32 v34, 1, v0
    v_and_b32 v35, 1, v0
    v_lshlrev_b32 v35, 4, v35
    s_lshl_b32 s56, s2, 5
    s_add_u32 s56, s56, 0x401000
    v_lshl_add_u32 v38, v34, 13, v35
    v_add_u32 v38, s56, v38
    global_store_dwordx4 v38, v[24:27], s[20:21] sc1
    v_add_u32 v38, 0x201000, v38
    global_store_dwordx4 v38, v[24:27], s[20:21] sc1
    v_add_u32 v38, 0x201000, v38
    global_store_dwordx4 v38, v[24:27], s[20:21] sc1
    v_add_u32 v38, 0x201000, v38
    global_store_dwordx4 v38, v[24:27], s[20:21] sc1
    v_add_u32 v38, 0x201000, v38
    s_and_b32 s56, s2, 7
    s_lshl_b32 s56, s56, 5
    s_lshr_b32 s86, s2, 3
    s_add_u32 s56, s56, s86
    s_lshl_b32 s56, s56, 5
    s_add_u32 s56, s56, 0x10000
    v_and_b32 v34, 7, v0
    v_lshl_add_u32 v34, v34, 13, s56
    global_store_dwordx2 v34, v[24:25], s[20:21] sc1
    s_add_u32 m0, s57, 0x20000
    v_add_u32 v44, 0x0, v13
    global_load_lds_dwordx4 v44, s[12:13]
    s_add_u32 m0, s57, 0x20400
    v_add_u32 v44, 0x1000, v13
    global_load_lds_dwordx4 v44, s[12:13]
    s_add_u32 m0, s57, 0x20800
    v_add_u32 v44, 0x2000, v13
    global_load_lds_dwordx4 v44, s[12:13]
    s_add_u32 m0, s57, 0x20c00
    v_add_u32 v44, 0x3000, v13
    global_load_lds_dwordx4 v44, s[12:13]
    s_waitcnt vmcnt(0)
    s_barrier
    v_add_u32 v44, 0x20000, v6
    ds_read_b64_tr_b16 v[48:49], v44 offset:0
    ds_read_b64_tr_b16 v[50:51], v44 offset:256
    ds_read_b64_tr_b16 v[52:53], v44 offset:1024
    ds_read_b64_tr_b16 v[54:55], v44 offset:1280
    ds_read_b64_tr_b16 v[56:57], v44 offset:2048
    ds_read_b64_tr_b16 v[58:59], v44 offset:2304
    ds_read_b64_tr_b16 v[60:61], v44 offset:3072
    ds_read_b64_tr_b16 v[62:63], v44 offset:3328
    ds_read_b64_tr_b16 v[64:65], v44 offset:4096
    ds_read_b64_tr_b16 v[66:67], v44 offset:4352
    ds_read_b64_tr_b16 v[68:69], v44 offset:5120
    ds_read_b64_tr_b16 v[70:71], v44 offset:5376
    ds_read_b64_tr_b16 v[72:73], v44 offset:6144
    ds_read_b64_tr_b16 v[74:75], v44 offset:6400
    ds_read_b64_tr_b16 v[76:77], v44 offset:7168
    ds_read_b64_tr_b16 v[78:79], v44 offset:7424
    s_mov_b32 s55, 0
L_pall:
    s_barrier
    v_lshrrev_b32 v24, 2, v1
    s_lshl_b32 s56, s45, 8
    s_add_u32 s56, s56, s55
    v_lshl_add_u32 v20, v24, 9, s56
    v_add_u32 v22, 0x2000, v20
    s_lshl_b32 s56, s44, 11
    s_add_u32 m0, s56, 0x10000
    s_nop 0
    buffer_load_dwordx4 v[20:21], s[24:27], 0 idxen offen lds
    s_add_u32 m0, s56, 0x10400
    s_nop 0
    buffer_load_dwordx4 v[22:23], s[24:27], 0 idxen offen lds
    s_waitcnt vmcnt(0)
    s_barrier
    s_mul_i32 s56, s45, 8192
    s_add_u32 s56, s56, 0x10000
    v_add_u32 v45, s56, v3
    v_add_u32 v46, s56, v4
    ds_read_b128 v[208:211], v45 offset:0
    ds_read_b128 v[212:215], v46 offset:0
    ds_read_b128 v[216:219], v45 offset:2048
    ds_read_b128 v[220:223], v46 offset:2048
    ds_read_b128 v[224:227], v45 offset:4096
    ds_read_b128 v[228:231], v46 offset:4096
    ds_read_b128 v[232:235], v45 offset:6144
    ds_read_b128 v[236:239], v46 offset:6144
    s_waitcnt lgkmcnt(0)
    v_mfma_f32_32x32x16_bf16 v[80:95], v[48:51], v[208:211], 0
    v_mfma_f32_32x32x16_bf16 v[80:95], v[52:55], v[212:215], v[80:95]
    v_mfma_f32_32x32x16_bf16 v[80:95], v[56:59], v[216:219], v[80:95]
    v_mfma_f32_32x32x16_bf16 v[80:95], v[60:63], v[220:223], v[80:95]
    v_mfma_f32_32x32x16_bf16 v[80:95], v[64:67], v[224:227], v[80:95]
    v_mfma_f32_32x32x16_bf16 v[80:95], v[68:71], v[228:231], v[80:95]
    v_mfma_f32_32x32x16_bf16 v[80:95], v[72:75], v[232:235], v[80:95]
    v_mfma_f32_32x32x16_bf16 v[80:95], v[76:79], v[236:239], v[80:95]
    s_add_u32 s56, s54, 0x4000
    v_add_u32 v26, s56, v12
    v_xor_b32 v27, 16, v26
    v_lshl_add_u32 v40, v1, 4, s56
    s_nop 7
    v_pk_mul_f32 v[80:81], v[80:81], s[94:95]
    v_pk_mul_f32 v[82:83], v[82:83], s[94:95]
    v_pk_mul_f32 v[84:85], v[84:85], s[94:95]
    v_pk_mul_f32 v[86:87], v[86:87], s[94:95]
    v_pk_mul_f32 v[88:89], v[88:89], s[94:95]
    v_pk_mul_f32 v[90:91], v[90:91], s[94:95]
    v_pk_mul_f32 v[92:93], v[92:93], s[94:95]
    v_pk_mul_f32 v[94:95], v[94:95], s[94:95]
    v_cvt_pk_bf16_f32 v96, v80, v81
    v_cvt_pk_bf16_f32 v97, v82, v83
    v_cvt_pk_bf16_f32 v98, v84, v85
    v_cvt_pk_bf16_f32 v99, v86, v87
    v_cvt_pk_bf16_f32 v100, v88, v89
    v_cvt_pk_bf16_f32 v101, v90, v91
    v_cvt_pk_bf16_f32 v102, v92, v93
    v_cvt_pk_bf16_f32 v103, v94, v95
    ds_write_b128 v26, v[96:99]
    ds_write_b128 v27, v[100:103]
    ds_read_b128 v[96:99], v40
    ds_read_b128 v[100:103], v40 offset:1024
    s_waitcnt lgkmcnt(1)
    buffer_store_dwordx4 v[96:99], v[20:21], s[28:31], 0 idxen offen sc1
    s_waitcnt lgkmcnt(0)
    buffer_store_dwordx4 v[100:103], v[22:23], s[28:31], 0 idxen offen sc1
    s_add_u32 s55, s55, 1
    s_cmp_lt_u32 s55, 256
    s_cbranch_scc1 L_pall
    s_waitcnt vmcnt(0)
L_scan:
    s_mov_b32 s55, 0
    s_mov_b32 s53, 0
    s_mov_b64 s[90:91], 0
L_scan_reset:
    s_barrier
    v_mov_b32 v24, 0
    v_mov_b32 v25, 0
    v_mov_b32 v26, 0
    v_mov_b32 v27, 0
    v_lshlrev_b32 v32, 4, v0
    ds_write_b128 v32, v[24:27] offset:0
    ds_write_b128 v32, v[24:27] offset:8192
    ds_write_b128 v32, v[24:27] offset:16384
    ds_write_b128 v32, v[24:27] offset:24576
    ds_write_b128 v32, v[24:27] offset:32768
    ds_write_b128 v32, v[24:27] offset:40960
    ds_write_b128 v32, v[24:27] offset:49152
    v_cmp_lt_u32 vcc, 31, v0
    s_nop 1
    v_cndmask_b32_e64 v28, 0, -1, vcc
    v_mov_b32 v29, v28
    v_mov_b32 v30, v28
    v_mov_b32 v31, v28
    v_cmp_gt_u32 vcc, 352, v0
    s_and_b64 exec, vcc, -1
    s_cbranch_execz L_rl_b
    ds_write_b128 v32, v[28:31] offset:57344
L_rl_b:
    s_mov_b64 exec, -1
    v_mov_b32 v32, 64000
    ds_write_b64 v32, v[24:25]
    s_waitcnt lgkmcnt(0)
    s_barrier
    s_cmp_lg_u32 s51, 3
    s_cbranch_scc0 L_scan_retry
L_scan_step:
    v_add_u32 v209, s53, v0
    v_lshlrev_b32 v26, 2, v209
    buffer_load_dword v34, v26, s[36:39], 0 offen
    buffer_load_dword v35, v26, s[40:43], 0 offen
    s_add_u32 s53, s53, 512
    v_cmp_gt_u32 vcc, 160000, v209
    s_mov_b64 s[90:91], vcc
    s_waitcnt vmcnt(0)
    v_bfe_u32 v24, v34, 9, 5
    v_and_b32 v208, 0x13, v24
    v_and_b32 v25, 4, v24
    v_lshl_or_b32 v208, v25, 1, v208
    v_bfe_u32 v25, v24, 3, 1
    v_lshl_or_b32 v208, v25, 2, v208
    v_bfe_u32 v25, v34, 8, 1
    v_lshl_or_b32 v208, v25, 5, v208
    v_and_b32 v25, 0x3fff, v35
    v_lshl_or_b32 v208, v208, 14, v25
    v_and_b32 v34, 255, v34
    v_cmp_eq_u32 vcc, s2, v34
    s_and_b64 s[90:91], s[90:91], vcc
L_scan_retry:
    s_mov_b64 exec, s[90:91]
    s_cbranch_execz L_scan_b
    v_mov_b32 v168, v209
    v_bfe_u32 v160, v208, 19, 1
    v_lshlrev_b32 v160, 2, v160
    ds_add_rtn_u32 v160, v160, v15 offset:64000
    v_lshlrev_b32 v168, 3, v168
    buffer_load_dwordx2 v[80:81], v168, s[32:35], 0 offen
    s_waitcnt lgkmcnt(0)
    v_cmp_gt_u32 vcc, 448, v160
    s_andn2_b64 s[90:91], s[90:91], vcc
    s_and_b64 exec, exec, vcc
    v_bfe_u32 v24, v208, 19, 1
    v_lshlrev_b32 v24, 4, v24
    v_mul_u32_u24 v25, 160, v24
    v_lshl_add_u32 v25, v160, 2, v25
    v_lshlrev_b32 v160, 4, v160
    v_and_b32 v16, 0x3fff, v208
    ds_write_b32 v25, v16 offset:57856
    v_bfe_u32 v25, v208, 17, 3
    v_mad_u32_u24 v25, v25, v14, v160
    v_bfe_u32 v16, v208, 14, 3
    v_lshl_add_u32 v25, v16, 1, v25
    ds_write_b16 v25, v17
    v_mad_u32_u24 v160, v24, s59, v160
    s_waitcnt vmcnt(0)
    ds_write_b64 v160, v[80:81] offset:21696
L_scan_b:
    s_mov_b64 exec, -1
    s_waitcnt lgkmcnt(0)
    s_barrier
    v_mov_b32 v24, 64000
    ds_read_b64 v[28:29], v24
    s_waitcnt lgkmcnt(0)
    v_max_u32 v31, v28, v29
    s_nop 0
    v_readfirstlane_b32 s56, v31
    s_mov_b32 s51, 3
    s_cmp_gt_u32 s56, 448
    s_cbranch_scc1 L_flush
    s_mov_b32 s51, 4
    s_cmp_ge_u32 s53, 160000
    s_cbranch_scc1 L_flush
    s_barrier
    s_branch L_scan_step
L_slow_ret:
    s_waitcnt vmcnt(0)
    s_cmp_eq_u32 s51, 4
    s_cbranch_scc1 L_epi
    s_branch L_scan_reset
L_codeend:
.section .rodata,"a"
.p2align 6
.amdhsa_kernel gather_scatter__mpnn_edge_mlp__graph_kernel
  .amdhsa_next_free_vgpr 256
  .amdhsa_next_free_sgpr 102
  .amdhsa_accum_offset 256
  .amdhsa_group_segment_fixed_size 0
  .amdhsa_kernarg_size 72
  .amdhsa_user_sgpr_count 2
  .amdhsa_user_sgpr_kernarg_segment_ptr 1
  .amdhsa_system_sgpr_workgroup_id_x 1
.end_amdhsa_kernel
```
